```python
import torch

def _softmax(x, axis=-1):
    return torch.softmax(x, dim=axis)
def _gelu(x):
    return torch.nn.functional.gelu(x, approximate="tanh")
def _silu(x):
    return torch.nn.functional.silu(x)
def _sigmoid(x):
    return torch.sigmoid(x)
def _layernorm(x, axis=-1, eps=1e-5):
    m = x.mean(dim=axis, keepdim=True)
    v = x.var(dim=axis, keepdim=True, unbiased=False)
    return (x - m) / torch.sqrt(v + eps)
def _scatter_add(tgt, idx, src, axis=0):
    return tgt.clone().index_add_(axis, idx, src)
def _segment_sum(src, seg, n):
    out = torch.zeros((n,) + src.shape[1:], dtype=src.dtype)
    return out.index_add_(0, seg, src)
def _pad(x, pw):
    flat = tuple(v for pair in reversed(pw) for v in pair)
    return torch.nn.functional.pad(x, flat)

kernel_name = 'standalone__gqa_block_cached__decode'

def setup_inputs():

    _w = (lambda a: (lambda t: t.to(torch.bfloat16) if t.is_floating_point() else t)(torch.as_tensor(a)))
    B, Sq, D = 4, 1, 512
    Hq, Hkv, Sk, Dh = 32, 8, 16384, 128
    assert Hq % Hkv == 0, (Hq, Hkv)
    return {
        "x": _w((lambda *s: torch.randn(*s, dtype=torch.bfloat16) * 0.8)(B, Sq, D)),
        "k_cache": _w((lambda *s: torch.randn(*s, dtype=torch.bfloat16) * 0.8)(B, Hkv, Sk, Dh)),
        "v_cache": _w((lambda *s: torch.randn(*s, dtype=torch.bfloat16) * 0.05)(B, Hkv, Sk, Dh)),
        "wq": _w((lambda *s: torch.randn(*s, dtype=torch.bfloat16) * 0.8)(D, Hq * Dh) * (D ** -0.5)),
        "wo": _w((lambda *s: torch.randn(*s, dtype=torch.bfloat16) * 0.05)(Hq * Dh, D) * ((Hq * Dh) ** -0.5)),
    }

def reference(x, k_cache, v_cache, wq, wo):
    B, Sq, D = x.shape
    Hq, Dh = 32, 128
    Hkv = k_cache.shape[1]
    rep = Hq // Hkv
    q = (lambda x, *d: x.permute(*d))((x @ wq).reshape(B, Sq, Hq, Dh), 0, 2, 1, 3)
    k = (lambda x, n, axis: torch.repeat_interleave(x, n, dim=axis))(k_cache, rep, axis=1)
    v = (lambda x, n, axis: torch.repeat_interleave(x, n, dim=axis))(v_cache, rep, axis=1)
    scores = torch.einsum("bhqd,bhkd->bhqk", q, k) * (Dh ** -0.5)
    p = _softmax(scores, axis=-1)
    o = torch.einsum("bhqk,bhkd->bhqd", p, v)
    return (lambda x, *d: x.permute(*d))(o, 0, 2, 1, 3).reshape(B, Sq, Hq * Dh) @ wo
```

```asm
; @launch grid=(256,1,1) block=(320,1,1) lds=25760
.amdgcn_target "amdgcn-amd-amdhsa--gfx950"
.text
.p2align 12
.fill 832, 4, 0xbf810000
.globl standalone__gqa_block_cached__decode_kernel
.p2align 8
.type standalone__gqa_block_cached__decode_kernel,@function
standalone__gqa_block_cached__decode_kernel:
    s_cmp_ge_u32 s2, 256
    s_cbranch_scc1 L_end
    s_load_dwordx16 s[4:19], s[0:1], 0
    v_lshrrev_b32 v2, 6, v0
    v_and_b32 v1, 63, v0
    s_lshr_b32 s21, s2, 3
    v_readfirstlane_b32 s20, v2
    s_and_b32 s22, s2, 7
    v_lshlrev_b32 v3, 4, v1
    s_mov_b32 s27, 0x20000
    s_mov_b32 s31, 0x20000
    s_and_b32 s54, s21, 24
    s_add_u32 s54, s54, s22
    s_and_b32 s55, s21, 7
    s_lshl_b32 s56, s54, 3
    s_add_u32 s56, s56, s55
    s_lshr_b32 s53, s21, 3
    s_lshl_b32 s34, s53, 20
    s_lshl_b32 s35, s22, 10
    s_add_u32 s34, s34, s35
    s_lshl_b32 s35, s55, 7
    s_add_u32 s34, s34, s35
    s_cmp_lg_u32 s20, 0
    s_cbranch_scc1 L_stream
    v_mov_b32 v8, -1
    v_mov_b32 v9, -1
    v_mov_b32 v10, -1
    v_mov_b32 v11, -1
    v_mov_b32 v5, 0
    ds_write_b128 v3, v[8:11] offset:16384
    ds_write_b128 v5, v[8:11] offset:25728
    ds_write_b128 v5, v[8:11] offset:25744
    s_mul_i32 s52, s54, 4352
    s_add_u32 s52, s52, 851968
    v_lshrrev_b32 v6, 4, v1
    v_and_b32 v14, 3, v1
    v_lshlrev_b32 v4, 10, v14
    v_lshl_add_u32 v4, v6, 4, v4
    s_lshl_b32 s35, s53, 8
    v_add_u32 v4, s35, v4
    v_and_b32 v7, 8, v1
    v_lshl_add_u32 v7, v7, 3, v1
    v_lshl_add_u32 v7, v7, 2, s52
    s_and_b32 s38, s21, 3
    s_lshl_b32 s39, s22, 2
    s_add_u32 s38, s38, s39
    s_lshr_b32 s39, s21, 2
    s_lshl_b32 s35, s38, 3
    s_add_u32 s35, s35, s39
    s_lshl_b32 s35, s35, 10
    s_add_u32 s35, s35, 589824
    v_add_u32 v12, s35, v3
    s_waitcnt lgkmcnt(0)
    s_cmp_lg_u32 s55, 0
    s_cbranch_scc1 L_noclear
    s_mov_b64 exec, 0xff03
    global_store_dword v7, v5, s[18:19] sc1
    s_mov_b64 exec, -1
L_noclear:
    s_barrier
    global_load_dwordx4 v[96:99], v4, s[4:5] offset:0
    global_load_dwordx4 v[100:103], v4, s[4:5] offset:64
    global_load_dwordx4 v[104:107], v4, s[4:5] offset:128
    global_load_dwordx4 v[108:111], v4, s[4:5] offset:192
    global_store_dwordx4 v12, v[8:11], s[18:19] sc1
    s_branch L_helper1
L_stream:
    s_setprio 1
    v_and_b32 v6, 3, v1
    v_lshlrev_b32 v2, 4, v6
    v_bfe_u32 v7, v1, 2, 2
    v_lshl_add_u32 v2, v7, 8, v2
    v_lshrrev_b32 v7, 4, v1
    v_lshl_add_u32 v2, v7, 6, v2
    v_lshrrev_b32 v7, 3, v1
    v_lshlrev_b32 v7, 13, v7
    v_and_b32 v8, 7, v1
    v_lshl_add_u32 v7, v8, 4, v7
    s_sub_u32 s40, s20, 1
    s_lshl_b32 m0, s40, 12
    s_lshl_b32 s33, s55, 2
    s_add_u32 s33, s33, s40
    s_lshl_b32 s33, s33, 12
    s_lshl_b32 s35, s53, 3
    s_lshr_b32 s35, 0x190a1300, s35
    s_and_b32 s35, s35, 31
    s_lshl_b32 s35, s35, 17
    s_add_u32 s33, s33, s35
    s_lshl_b32 s40, s40, 18
    s_sub_u32 s38, 0x400000, s34
    s_mov_b32 s39, 0x20000
    s_lshl_b32 s35, s54, 22
    s_mov_b32 s26, 0x400000
    s_mov_b32 s30, 0x400000
    s_waitcnt lgkmcnt(0)
    s_add_u32 s36, s10, s34
    s_addc_u32 s37, s11, 0
    s_add_u32 s24, s6, s35
    s_addc_u32 s25, s7, 0
    s_add_u32 s28, s8, s35
    s_addc_u32 s29, s9, 0
    s_barrier
    buffer_load_dwordx4 v7, s[36:39], s40 offen nt lds
    s_add_u32 m0, m0, 0x400
    s_add_u32 s40, s40, 0x10000
    buffer_load_dwordx4 v7, s[36:39], s40 offen nt lds
    s_add_u32 m0, m0, 0x400
    s_add_u32 s40, s40, 0x10000
    buffer_load_dwordx4 v7, s[36:39], s40 offen nt lds
    s_add_u32 m0, m0, 0x400
    s_add_u32 s40, s40, 0x10000
    buffer_load_dwordx4 v7, s[36:39], s40 offen nt lds
    buffer_load_dwordx4 v[56:59], v2, s[24:27], s33 offen offset:0 sc1 nt
    v_mov_b32 v7, 0xffff
    v_mov_b32 v23, 0xffff0000
    v_cmp_eq_u32 vcc, 0, v6
    v_cmp_eq_u32 s[46:47], 1, v6
    v_cmp_eq_u32 s[48:49], 2, v6
    v_cmp_eq_u32 s[50:51], 3, v6
    v_cndmask_b32 v4, 0, v7, vcc
    v_cndmask_b32 v4, v4, v23, s[46:47]
    v_cndmask_b32 v5, 0, v7, s[48:49]
    v_cndmask_b32 v5, v5, v23, s[50:51]
    v_mov_b32 v20, 0xff7fffff
    v_mov_b32 v21, 0
    v_mov_b32 v12, 0
    v_mov_b32 v13, 0
    v_mov_b32 v14, 0
    v_mov_b32 v15, 0
    v_mov_b32 v16, 0
    v_mov_b32 v17, 0
    v_mov_b32 v18, 0
    v_mov_b32 v19, 0
    s_mov_b32 s42, 0x3e0293ee
    s_lshl_b32 s40, s20, 2
    s_sub_u32 s40, s40, 4
    v_mov_b32 v48, s40
    s_waitcnt vmcnt(4)
    buffer_load_dwordx4 v[60:63], v2, s[24:27], s33 offen offset:1024 sc1 nt
    s_waitcnt vmcnt(4)
    buffer_load_dwordx4 v[64:67], v2, s[24:27], s33 offen offset:2048 sc1 nt
    s_waitcnt vmcnt(4)
    buffer_load_dwordx4 v[68:71], v2, s[24:27], s33 offen offset:3072 sc1 nt
    s_waitcnt vmcnt(4)
    buffer_load_dwordx4 v[72:75], v3, s[28:31], s33 offen offset:0 sc1 nt
    s_mov_b64 exec, 1
    ds_write_b32 v48, v48 offset:25744
    s_mov_b64 exec, -1
    s_waitcnt vmcnt(4)
    buffer_load_dwordx4 v[76:79], v3, s[28:31], s33 offen offset:1024 sc1 nt
    s_waitcnt vmcnt(4)
    buffer_load_dwordx4 v[80:83], v3, s[28:31], s33 offen offset:2048 sc1 nt
    s_waitcnt vmcnt(4)
    buffer_load_dwordx4 v[84:87], v3, s[28:31], s33 offen offset:3072 sc1 nt
    s_waitcnt vmcnt(4)
    s_add_u32 s33, s33, 0x20000
    s_and_b32 s33, s33, 0x3fffff
    buffer_load_dwordx4 v[88:91], v2, s[24:27], s33 offen offset:0 sc1 nt
    s_waitcnt vmcnt(4)
    buffer_load_dwordx4 v[92:95], v2, s[24:27], s33 offen offset:1024 sc1 nt
    s_waitcnt vmcnt(4)
    buffer_load_dwordx4 v[96:99], v2, s[24:27], s33 offen offset:2048 sc1 nt
    s_waitcnt vmcnt(4)
    buffer_load_dwordx4 v[100:103], v2, s[24:27], s33 offen offset:3072 sc1 nt
    s_waitcnt vmcnt(4)
    buffer_load_dwordx4 v[104:107], v3, s[28:31], s33 offen offset:0 sc1 nt
    s_waitcnt vmcnt(4)
    buffer_load_dwordx4 v[108:111], v3, s[28:31], s33 offen offset:1024 sc1 nt
    s_waitcnt vmcnt(4)
    buffer_load_dwordx4 v[112:115], v3, s[28:31], s33 offen offset:2048 sc1 nt
    s_waitcnt vmcnt(4)
    buffer_load_dwordx4 v[116:119], v3, s[28:31], s33 offen offset:3072 sc1 nt
    s_waitcnt vmcnt(4)
    s_add_u32 s33, s33, 0x20000
    s_and_b32 s33, s33, 0x3fffff
    buffer_load_dwordx4 v[120:123], v2, s[24:27], s33 offen offset:0 sc1 nt
    s_waitcnt vmcnt(4)
    buffer_load_dwordx4 v[124:127], v2, s[24:27], s33 offen offset:1024 sc1 nt
    s_waitcnt vmcnt(4)
    buffer_load_dwordx4 v[128:131], v2, s[24:27], s33 offen offset:2048 sc1 nt
    s_waitcnt vmcnt(4)
    buffer_load_dwordx4 v[132:135], v2, s[24:27], s33 offen offset:3072 sc1 nt
    s_waitcnt vmcnt(4)
    buffer_load_dwordx4 v[136:139], v3, s[28:31], s33 offen offset:0 sc1 nt
    s_waitcnt vmcnt(4)
    buffer_load_dwordx4 v[140:143], v3, s[28:31], s33 offen offset:1024 sc1 nt
    s_waitcnt vmcnt(4)
    buffer_load_dwordx4 v[144:147], v3, s[28:31], s33 offen offset:2048 sc1 nt
    s_waitcnt vmcnt(4)
    buffer_load_dwordx4 v[148:151], v3, s[28:31], s33 offen offset:3072 sc1 nt
    s_waitcnt vmcnt(4)
    s_add_u32 s33, s33, 0x20000
    s_and_b32 s33, s33, 0x3fffff
    buffer_load_dwordx4 v[152:155], v2, s[24:27], s33 offen offset:0 sc1 nt
    s_waitcnt vmcnt(4)
    buffer_load_dwordx4 v[156:159], v2, s[24:27], s33 offen offset:1024 sc1 nt
    s_waitcnt vmcnt(4)
    buffer_load_dwordx4 v[160:163], v2, s[24:27], s33 offen offset:2048 sc1 nt
    s_waitcnt vmcnt(4)
    buffer_load_dwordx4 v[164:167], v2, s[24:27], s33 offen offset:3072 sc1 nt
    s_waitcnt vmcnt(4)
    buffer_load_dwordx4 v[168:171], v3, s[28:31], s33 offen offset:0 sc1 nt
    s_waitcnt vmcnt(4)
    buffer_load_dwordx4 v[172:175], v3, s[28:31], s33 offen offset:1024 sc1 nt
    s_waitcnt vmcnt(4)
    buffer_load_dwordx4 v[176:179], v3, s[28:31], s33 offen offset:2048 sc1 nt
    s_waitcnt vmcnt(4)
    buffer_load_dwordx4 v[180:183], v3, s[28:31], s33 offen offset:3072 sc1 nt
    s_waitcnt vmcnt(4)
    s_add_u32 s33, s33, 0x20000
    s_and_b32 s33, s33, 0x3fffff
    buffer_load_dwordx4 v[184:187], v2, s[24:27], s33 offen offset:0 sc1 nt
    s_waitcnt vmcnt(4)
    buffer_load_dwordx4 v[188:191], v2, s[24:27], s33 offen offset:1024 sc1 nt
    s_waitcnt vmcnt(4)
    buffer_load_dwordx4 v[192:195], v2, s[24:27], s33 offen offset:2048 sc1 nt
    s_waitcnt vmcnt(4)
    buffer_load_dwordx4 v[196:199], v2, s[24:27], s33 offen offset:3072 sc1 nt
    s_waitcnt vmcnt(4)
    buffer_load_dwordx4 v[200:203], v3, s[28:31], s33 offen offset:0 sc1 nt
    s_waitcnt vmcnt(4)
    buffer_load_dwordx4 v[204:207], v3, s[28:31], s33 offen offset:1024 sc1 nt
    s_waitcnt vmcnt(4)
    buffer_load_dwordx4 v[208:211], v3, s[28:31], s33 offen offset:2048 sc1 nt
    s_waitcnt vmcnt(4)
    buffer_load_dwordx4 v[212:215], v3, s[28:31], s33 offen offset:3072 sc1 nt
    s_waitcnt vmcnt(4)
    s_add_u32 s33, s33, 0x20000
    s_and_b32 s33, s33, 0x3fffff
    buffer_load_dwordx4 v[216:219], v2, s[24:27], s33 offen offset:0 sc1 nt
    s_waitcnt vmcnt(4)
    buffer_load_dwordx4 v[220:223], v2, s[24:27], s33 offen offset:1024 sc1 nt
    s_waitcnt vmcnt(4)
    buffer_load_dwordx4 v[224:227], v2, s[24:27], s33 offen offset:2048 sc1 nt
    s_waitcnt vmcnt(4)
    buffer_load_dwordx4 v[228:231], v2, s[24:27], s33 offen offset:3072 sc1 nt
    s_waitcnt vmcnt(4)
    buffer_load_dwordx4 v[232:235], v3, s[28:31], s33 offen offset:0 sc1 nt
    s_waitcnt vmcnt(4)
    buffer_load_dwordx4 v[236:239], v3, s[28:31], s33 offen offset:1024 sc1 nt
    s_waitcnt vmcnt(4)
    buffer_load_dwordx4 v[240:243], v3, s[28:31], s33 offen offset:2048 sc1 nt
    s_waitcnt vmcnt(4)
    buffer_load_dwordx4 v[244:247], v3, s[28:31], s33 offen offset:3072 sc1 nt
    s_branch L_stream2
L_helper1:
    s_getpc_b64 s[36:37]
L_pc:
    s_sub_u32 s36, s36, L_pc-standalone__gqa_block_cached__decode_kernel
    s_subb_u32 s37, s37, 0
    v_lshl_add_u32 v4, v1, 5, s21
    v_lshlrev_b32 v4, 7, v4
    v_min_u32 v4, L_code_end-standalone__gqa_block_cached__decode_kernel-4, v4
    s_mov_b64 exec, 7
    global_load_dword v25, v4, s[36:37]
    s_mov_b64 exec, -1
    s_lshl_b32 s35, s22, 5
    v_lshlrev_b32 v22, 5, v1
    s_cmp_lg_u32 s55, 0
    s_cbranch_scc1 L_nosig
    s_add_u32 s46, s16, s35
    s_addc_u32 s47, s17, 0
    s_mov_b32 s48, 1
    s_waitcnt vmcnt(6)
    s_atomic_add s48, s[46:47], 0x0
L_nosig:
    v_and_b32 v7, 15, v1
    v_lshrrev_b32 v13, 2, v7
    v_lshrrev_b32 v2, 3, v1
    v_and_b32 v4, 7, v1
    v_lshlrev_b32 v4, 4, v4
    v_lshl_add_u32 v2, v2, 10, v4
    s_mul_i32 s41, s22, 4352
    s_add_u32 s41, s41, 851968
    v_mul_u32_u24 v30, 34816, v1
    v_add_u32 v30, s41, v30
    v_lshlrev_b32 v15, 16, v14
    v_lshl_add_u32 v15, v13, 6, v15
    v_lshl_add_u32 v15, v6, 4, v15
    s_lshl_b32 s35, s22, 13
    s_lshl_b32 s41, s21, 8
    s_add_u32 s35, s35, s41
    v_add_u32 v15, s35, v15
    v_lshlrev_b32 v23, 5, v14
    v_lshl_add_u32 v23, v13, 9, v23
    v_lshl_add_u32 v23, v6, 7, v23
    s_lshl_b32 s35, s54, 13
    v_add_u32 v23, s35, v23
    v_add_u32 v29, 0x1000, v23
    v_lshl_add_u32 v13, v6, 3, v13
    v_lshlrev_b32 v13, 7, v13
    v_lshl_add_u32 v13, v14, 3, v13
    s_lshl_b32 s35, s56, 10
    s_add_u32 s35, s35, 262144
    v_add_u32 v20, s35, v3
    s_lshl_b32 s35, s56, 7
    s_add_u32 s35, s35, 524288
    v_add_u32 v21, s35, v3
    s_mov_b32 s49, 0
L_waitw:
    ds_read_b128 v[16:19], v5 offset:25744
    s_add_u32 s49, s49, 1
    s_waitcnt lgkmcnt(0)
    v_max3_u32 v16, v16, v17, v18
    v_max_u32 v16, v16, v19
    v_cmp_eq_u32 vcc, -1, v16
    s_cbranch_vccz L_havew
    s_sleep 1
    s_cmp_lt_u32 s49, 8000000
    s_cbranch_scc1 L_waitw
L_havew:
    s_waitcnt vmcnt(2)
    ds_read_b64_tr_b16 v[32:33], v13 offset:0
    ds_read_b64_tr_b16 v[34:35], v13 offset:512
    ds_read_b64_tr_b16 v[36:37], v13 offset:32
    ds_read_b64_tr_b16 v[38:39], v13 offset:544
    ds_read_b64_tr_b16 v[40:41], v13 offset:64
    ds_read_b64_tr_b16 v[42:43], v13 offset:576
    ds_read_b64_tr_b16 v[44:45], v13 offset:96
    ds_read_b64_tr_b16 v[46:47], v13 offset:608
    ds_read_b64_tr_b16 v[48:49], v13 offset:4096
    ds_read_b64_tr_b16 v[50:51], v13 offset:4608
    ds_read_b64_tr_b16 v[52:53], v13 offset:4128
    ds_read_b64_tr_b16 v[54:55], v13 offset:4640
    s_waitcnt lgkmcnt(10)
    v_mfma_f32_16x16x32_bf16 v[160:163], v[32:35], v[96:99], 0
    ds_read_b64_tr_b16 v[56:57], v13 offset:4160
    ds_read_b64_tr_b16 v[58:59], v13 offset:4672
    s_waitcnt lgkmcnt(10)
    v_mfma_f32_16x16x32_bf16 v[164:167], v[36:39], v[96:99], 0
    ds_read_b64_tr_b16 v[60:61], v13 offset:4192
    ds_read_b64_tr_b16 v[62:63], v13 offset:4704
    s_waitcnt lgkmcnt(10)
    v_mfma_f32_16x16x32_bf16 v[168:171], v[40:43], v[96:99], 0
    ds_read_b64_tr_b16 v[64:65], v13 offset:8192
    ds_read_b64_tr_b16 v[66:67], v13 offset:8704
    s_waitcnt lgkmcnt(10)
    v_mfma_f32_16x16x32_bf16 v[172:175], v[44:47], v[96:99], 0
    ds_read_b64_tr_b16 v[68:69], v13 offset:8224
    ds_read_b64_tr_b16 v[70:71], v13 offset:8736
    s_waitcnt lgkmcnt(10)
    v_mfma_f32_16x16x32_bf16 v[160:163], v[48:51], v[100:103], v[160:163]
    ds_read_b64_tr_b16 v[72:73], v13 offset:8256
    ds_read_b64_tr_b16 v[74:75], v13 offset:8768
    s_waitcnt lgkmcnt(10)
    v_mfma_f32_16x16x32_bf16 v[164:167], v[52:55], v[100:103], v[164:167]
    ds_read_b64_tr_b16 v[76:77], v13 offset:8288
    ds_read_b64_tr_b16 v[78:79], v13 offset:8800
    s_waitcnt lgkmcnt(10)
    v_mfma_f32_16x16x32_bf16 v[168:171], v[56:59], v[100:103], v[168:171]
    ds_read_b64_tr_b16 v[80:81], v13 offset:12288
    ds_read_b64_tr_b16 v[82:83], v13 offset:12800
    s_waitcnt lgkmcnt(10)
    v_mfma_f32_16x16x32_bf16 v[172:175], v[60:63], v[100:103], v[172:175]
    ds_read_b64_tr_b16 v[84:85], v13 offset:12320
    ds_read_b64_tr_b16 v[86:87], v13 offset:12832
    s_waitcnt lgkmcnt(10)
    v_mfma_f32_16x16x32_bf16 v[160:163], v[64:67], v[104:107], v[160:163]
    ds_read_b64_tr_b16 v[88:89], v13 offset:12352
    ds_read_b64_tr_b16 v[90:91], v13 offset:12864
    s_waitcnt lgkmcnt(10)
    v_mfma_f32_16x16x32_bf16 v[164:167], v[68:71], v[104:107], v[164:167]
    ds_read_b64_tr_b16 v[92:93], v13 offset:12384
    ds_read_b64_tr_b16 v[94:95], v13 offset:12896
    s_waitcnt lgkmcnt(10)
    v_mfma_f32_16x16x32_bf16 v[168:171], v[72:75], v[104:107], v[168:171]
    s_waitcnt lgkmcnt(8)
    v_mfma_f32_16x16x32_bf16 v[172:175], v[76:79], v[104:107], v[172:175]
    s_waitcnt lgkmcnt(6)
    v_mfma_f32_16x16x32_bf16 v[160:163], v[80:83], v[108:111], v[160:163]
    s_waitcnt lgkmcnt(4)
    v_mfma_f32_16x16x32_bf16 v[164:167], v[84:87], v[108:111], v[164:167]
    s_waitcnt lgkmcnt(2)
    v_mfma_f32_16x16x32_bf16 v[168:171], v[88:91], v[108:111], v[168:171]
    s_waitcnt lgkmcnt(0)
    v_mfma_f32_16x16x32_bf16 v[172:175], v[92:95], v[108:111], v[172:175]
    s_nop 5
    v_mov_b32_dpp v160, v164 quad_perm:[0,1,2,3] row_mask:0xf bank_mask:0x2
    v_mov_b32_dpp v161, v165 quad_perm:[0,1,2,3] row_mask:0xf bank_mask:0x2
    v_mov_b32_dpp v162, v166 quad_perm:[0,1,2,3] row_mask:0xf bank_mask:0x2
    v_mov_b32_dpp v163, v167 quad_perm:[0,1,2,3] row_mask:0xf bank_mask:0x2
    v_mov_b32_dpp v160, v168 quad_perm:[0,1,2,3] row_mask:0xf bank_mask:0x4
    v_mov_b32_dpp v161, v169 quad_perm:[0,1,2,3] row_mask:0xf bank_mask:0x4
    v_mov_b32_dpp v162, v170 quad_perm:[0,1,2,3] row_mask:0xf bank_mask:0x4
    v_mov_b32_dpp v163, v171 quad_perm:[0,1,2,3] row_mask:0xf bank_mask:0x4
    v_mov_b32_dpp v160, v172 quad_perm:[0,1,2,3] row_mask:0xf bank_mask:0x8
    v_mov_b32_dpp v161, v173 quad_perm:[0,1,2,3] row_mask:0xf bank_mask:0x8
    v_mov_b32_dpp v162, v174 quad_perm:[0,1,2,3] row_mask:0xf bank_mask:0x8
    v_mov_b32_dpp v163, v175 quad_perm:[0,1,2,3] row_mask:0xf bank_mask:0x8
    global_store_dwordx4 v15, v[160:163], s[18:19]
    global_store_dwordx4 v20, v[8:11], s[18:19]
    s_mov_b64 exec, 0xff
    global_store_dwordx4 v21, v[8:11], s[18:19]
    s_mov_b64 exec, -1
    s_lshl_b32 s35, s38, 17
    s_lshl_b32 s41, s39, 7
    s_add_u32 s35, s35, s41
    s_add_u32 s24, s12, s35
    s_addc_u32 s25, s13, 0
    s_sub_u32 s26, 0x400000, s35
    s_mov_b32 m0, 0
    s_mov_b32 s33, 0
    s_waitcnt vmcnt(0)
    buffer_load_dwordx4 v2, s[24:27], s33 offen nt lds
    s_add_u32 m0, m0, 0x400
    s_add_u32 s33, s33, 0x2000
    s_waitcnt vmcnt(0)
    s_mov_b64 exec, 0xff
    s_getreg_b32 s59, hwreg(HW_REG_XCC_ID, 0, 3)
    s_lshl_b32 s59, s59, 2
    s_lshl_b32 s48, 1, s59
    s_add_u32 s46, s18, s52
    s_addc_u32 s47, s19, 0
    s_mov_b32 s49, 0
    s_branch L_pollflag1
L_pollflag:
    s_sleep 32
L_pollflag1:
    global_load_dword v24, v22, s[16:17] sc1
L_chkflag:
    s_add_u32 s49, s49, 1
    s_waitcnt vmcnt(0)
    v_cmp_gt_u32 vcc, 4, v24
    s_cbranch_vccz L_gotflag
    s_cmp_lt_u32 s49, 100000
    s_cbranch_scc1 L_pollflag
L_gotflag:
    s_atomic_add s48, s[46:47], 0x0
    s_mov_b64 exec, -1
    buffer_load_dwordx4 v2, s[24:27], s33 offen nt lds
    s_add_u32 m0, m0, 0x400
    s_add_u32 s33, s33, 0x2000
    s_waitcnt vmcnt(0)
    buffer_load_dwordx4 v2, s[24:27], s33 offen nt lds
    s_add_u32 m0, m0, 0x400
    s_add_u32 s33, s33, 0x2000
    s_waitcnt vmcnt(0)
    s_mov_b64 exec, 15
    s_mov_b32 s49, 0
    s_branch L_pollq1
L_pollq:
    s_sleep 24
L_pollq1:
    global_load_dword v24, v30, s[18:19] sc1
    s_add_u32 s49, s49, 1
    s_waitcnt vmcnt(0)
    v_and_b32 v25, 0x0f0f0f0f, v24
    v_lshrrev_b32 v26, 4, v24
    v_and_b32 v26, 0x0f0f0f0f, v26
    v_add_u32 v25, v25, v26
    v_sad_u8 v25, v25, 0, 0
    v_cmp_ne_u32 vcc, 8, v25
    s_cbranch_vccz L_gotq
    s_cmp_lt_u32 s49, 100000
    s_cbranch_scc1 L_pollq
L_gotq:
    s_waitcnt lgkmcnt(0)
    s_lshl_b32 s48, 8, s59
    v_cmp_ne_u32 vcc, s48, v24
    s_mov_b32 s59, 1
    s_mov_b64 exec, -1
    s_cbranch_vccz L_near
    s_mov_b32 s59, 0
    global_store_dwordx4 v15, v[160:163], s[18:19] sc1
    global_store_dwordx4 v20, v[8:11], s[18:19] sc1
    s_mov_b64 exec, 0xff
    global_store_dwordx4 v21, v[8:11], s[18:19] sc1
    s_mov_b64 exec, 15
    s_mov_b32 s48, 1
    s_waitcnt vmcnt(0)
    s_atomic_add s48, s[46:47], 0x4
L_pollq2:
    s_sleep 32
    global_load_dword v24, v30, s[18:19] offset:4 sc1
    s_add_u32 s49, s49, 1
    s_waitcnt vmcnt(0)
    v_cmp_ne_u32 vcc, 8, v24
    s_cbranch_vccz L_gotq2
    s_cmp_lt_u32 s49, 100000
    s_cbranch_scc1 L_pollq2
L_gotq2:
    s_mov_b64 exec, -1
L_near:
    global_load_dwordx4 v[32:35], v23, s[18:19] offset:0 sc1
    global_load_dwordx4 v[36:39], v23, s[18:19] offset:16 sc1
    global_load_dwordx4 v[40:43], v23, s[18:19] offset:2048 sc1
    global_load_dwordx4 v[44:47], v23, s[18:19] offset:2064 sc1
    global_load_dwordx4 v[48:51], v29, s[18:19] offset:0 sc1
    global_load_dwordx4 v[52:55], v29, s[18:19] offset:16 sc1
    global_load_dwordx4 v[56:59], v29, s[18:19] offset:2048 sc1
    global_load_dwordx4 v[60:63], v29, s[18:19] offset:2064 sc1
    s_waitcnt vmcnt(4)
    v_add_f32 v32, v32, v40
    v_add_f32 v33, v33, v41
    v_add_f32 v34, v34, v42
    v_add_f32 v35, v35, v43
    v_add_f32 v36, v36, v44
    v_add_f32 v37, v37, v45
    v_add_f32 v38, v38, v46
    v_add_f32 v39, v39, v47
    s_waitcnt vmcnt(0)
    v_add_f32 v48, v48, v56
    v_add_f32 v49, v49, v57
    v_add_f32 v50, v50, v58
    v_add_f32 v51, v51, v59
    v_add_f32 v52, v52, v60
    v_add_f32 v53, v53, v61
    v_add_f32 v54, v54, v62
    v_add_f32 v55, v55, v63
    v_add_f32 v32, v32, v48
    v_add_f32 v33, v33, v49
    v_add_f32 v34, v34, v50
    v_add_f32 v35, v35, v51
    v_add_f32 v36, v36, v52
    v_add_f32 v37, v37, v53
    v_add_f32 v38, v38, v54
    v_add_f32 v39, v39, v55
    v_cvt_pk_bf16_f32 v24, v32, v33
    v_cvt_pk_bf16_f32 v25, v34, v35
    v_cvt_pk_bf16_f32 v26, v36, v37
    v_cvt_pk_bf16_f32 v27, v38, v39
    v_min_u32 v24, -2, v24
    v_min_u32 v25, -2, v25
    v_min_u32 v26, -2, v26
    v_min_u32 v27, -2, v27
    ds_write_b128 v3, v[24:27] offset:16384
    s_branch L_helper2
L_rescale:
    v_mov_b32 v23, v22
    s_nop 1
    v_permlane16_swap_b32 v22, v23
    s_nop 1
    v_max_f32 v22, v22, v23
    v_mov_b32 v23, v22
    s_nop 1
    v_permlane32_swap_b32 v22, v23
    s_nop 1
    v_max3_f32 v22, v22, v23, v20
    v_sub_f32 v24, v20, v22
    v_exp_f32 v24, v24
    v_mov_b32 v20, v22
    v_mul_f32 v21, v21, v24
    s_nop 0
    v_mov_b32_dpp v25, v24 row_newbcast:0 row_mask:0x1 bank_mask:0xf
    s_nop 1
    v_mov_b32_dpp v25, v24 row_newbcast:4 row_mask:0x2 bank_mask:0xf
    s_nop 1
    v_mov_b32_dpp v25, v24 row_newbcast:8 row_mask:0x4 bank_mask:0xf
    s_nop 1
    v_mov_b32_dpp v25, v24 row_newbcast:12 row_mask:0x8 bank_mask:0xf
    s_nop 1
    v_mul_f32 v12, v12, v25
    v_mul_f32 v13, v13, v25
    v_mul_f32 v14, v14, v25
    v_mul_f32 v15, v15, v25
    v_mul_f32 v16, v16, v25
    v_mul_f32 v17, v17, v25
    v_mul_f32 v18, v18, v25
    v_mul_f32 v19, v19, v25
    s_setpc_b64 s[44:45]
L_stream2:
    s_mov_b32 s43, 0
L_waitq:
    ds_read_b128 v[8:11], v3 offset:16384
    s_add_u32 s43, s43, 1
    s_waitcnt lgkmcnt(0)
    v_max3_u32 v23, v8, v9, v10
    v_max_u32 v23, v23, v11
    v_cmp_eq_u32 vcc, -1, v23
    s_cbranch_vccz L_haveq
    s_sleep 1
    s_cmp_lt_u32 s43, 8000000
    s_cbranch_scc1 L_waitq
L_haveq:
    v_mfma_f32_16x16x32_bf16 v[28:31], v[56:59], v[8:11], 0
    v_mfma_f32_16x16x32_bf16 v[32:35], v[60:63], v[8:11], 0
    v_mfma_f32_16x16x32_bf16 v[36:39], v[64:67], v[8:11], 0
    v_mfma_f32_16x16x32_bf16 v[40:43], v[68:71], v[8:11], 0
    s_waitcnt vmcnt(4)
    s_add_u32 s33, s33, 0x20000
    s_and_b32 s33, s33, 0x3fffff
    buffer_load_dwordx4 v[56:59], v2, s[24:27], s33 offen offset:0 sc1 nt
    s_waitcnt vmcnt(4)
    buffer_load_dwordx4 v[60:63], v2, s[24:27], s33 offen offset:1024 sc1 nt
    s_nop 5
    v_mov_b32_dpp v44, v28 quad_perm:[0,0,0,0] row_mask:0xf bank_mask:0xf
    v_mov_b32_dpp v45, v32 quad_perm:[0,0,0,0] row_mask:0xf bank_mask:0xf
    v_mov_b32_dpp v46, v36 quad_perm:[0,0,0,0] row_mask:0xf bank_mask:0xf
    v_mov_b32_dpp v47, v40 quad_perm:[0,0,0,0] row_mask:0xf bank_mask:0xf
    v_add_f32_dpp v44, v29, v44 quad_perm:[1,1,1,1] row_mask:0xf bank_mask:0xf
    v_add_f32_dpp v45, v33, v45 quad_perm:[1,1,1,1] row_mask:0xf bank_mask:0xf
    v_add_f32_dpp v46, v37, v46 quad_perm:[1,1,1,1] row_mask:0xf bank_mask:0xf
    v_add_f32_dpp v47, v41, v47 quad_perm:[1,1,1,1] row_mask:0xf bank_mask:0xf
    v_add_f32_dpp v44, v30, v44 quad_perm:[2,2,2,2] row_mask:0xf bank_mask:0xf
    v_add_f32_dpp v45, v34, v45 quad_perm:[2,2,2,2] row_mask:0xf bank_mask:0xf
    v_add_f32_dpp v46, v38, v46 quad_perm:[2,2,2,2] row_mask:0xf bank_mask:0xf
    v_add_f32_dpp v47, v42, v47 quad_perm:[2,2,2,2] row_mask:0xf bank_mask:0xf
    v_add_f32_dpp v44, v31, v44 quad_perm:[3,3,3,3] row_mask:0xf bank_mask:0xf
    v_add_f32_dpp v45, v35, v45 quad_perm:[3,3,3,3] row_mask:0xf bank_mask:0xf
    v_add_f32_dpp v46, v39, v46 quad_perm:[3,3,3,3] row_mask:0xf bank_mask:0xf
    v_add_f32_dpp v47, v43, v47 quad_perm:[3,3,3,3] row_mask:0xf bank_mask:0xf
    v_max3_f32 v22, v44, v45, v46
    v_max_f32 v22, v22, v47
    v_mul_f32 v22, s42, v22
    v_cmp_gt_f32 vcc, v22, v20
    s_cbranch_vccz L_keepp0
    s_call_b64 s[44:45], L_rescale
L_keepp0:
    v_fma_f32 v44, v44, s42, -v20
    v_fma_f32 v45, v45, s42, -v20
    v_fma_f32 v46, v46, s42, -v20
    v_fma_f32 v47, v47, s42, -v20
    v_exp_f32 v44, v44
    v_exp_f32 v45, v45
    v_exp_f32 v46, v46
    v_exp_f32 v47, v47
    v_cvt_pk_bf16_f32 v49, v44, v44
    v_cvt_pk_bf16_f32 v51, v45, v45
    v_cvt_pk_bf16_f32 v53, v46, v46
    v_cvt_pk_bf16_f32 v55, v47, v47
    v_add_f32 v44, v44, v45
    v_add_f32 v46, v46, v47
    v_and_b32 v48, v49, v4
    v_and_b32 v49, v49, v5
    v_and_b32 v50, v51, v4
    v_and_b32 v51, v51, v5
    v_and_b32 v52, v53, v4
    v_and_b32 v53, v53, v5
    v_and_b32 v54, v55, v4
    v_and_b32 v55, v55, v5
    v_add_f32 v21, v21, v44
    v_add_f32 v21, v21, v46
    v_mfma_f32_16x16x16_bf16 v[12:15], v[48:49], v[72:73], v[12:15]
    v_mfma_f32_16x16x16_bf16 v[16:19], v[48:49], v[74:75], v[16:19]
    v_mfma_f32_16x16x16_bf16 v[12:15], v[50:51], v[76:77], v[12:15]
    v_mfma_f32_16x16x16_bf16 v[16:19], v[50:51], v[78:79], v[16:19]
    v_mfma_f32_16x16x16_bf16 v[12:15], v[52:53], v[80:81], v[12:15]
    v_mfma_f32_16x16x16_bf16 v[16:19], v[52:53], v[82:83], v[16:19]
    v_mfma_f32_16x16x16_bf16 v[12:15], v[54:55], v[84:85], v[12:15]
    v_mfma_f32_16x16x16_bf16 v[16:19], v[54:55], v[86:87], v[16:19]
    s_waitcnt vmcnt(4)
    buffer_load_dwordx4 v[64:67], v2, s[24:27], s33 offen offset:2048 sc1 nt
    s_waitcnt vmcnt(4)
    buffer_load_dwordx4 v[68:71], v2, s[24:27], s33 offen offset:3072 sc1 nt
    v_mfma_f32_16x16x32_bf16 v[28:31], v[88:91], v[8:11], 0
    v_mfma_f32_16x16x32_bf16 v[32:35], v[92:95], v[8:11], 0
    v_mfma_f32_16x16x32_bf16 v[36:39], v[96:99], v[8:11], 0
    v_mfma_f32_16x16x32_bf16 v[40:43], v[100:103], v[8:11], 0
    s_waitcnt vmcnt(4)
    buffer_load_dwordx4 v[72:75], v3, s[28:31], s33 offen offset:0 sc1 nt
    s_nop 5
    v_mov_b32_dpp v44, v28 quad_perm:[0,0,0,0] row_mask:0xf bank_mask:0xf
    v_mov_b32_dpp v45, v32 quad_perm:[0,0,0,0] row_mask:0xf bank_mask:0xf
    v_mov_b32_dpp v46, v36 quad_perm:[0,0,0,0] row_mask:0xf bank_mask:0xf
    v_mov_b32_dpp v47, v40 quad_perm:[0,0,0,0] row_mask:0xf bank_mask:0xf
    v_add_f32_dpp v44, v29, v44 quad_perm:[1,1,1,1] row_mask:0xf bank_mask:0xf
    v_add_f32_dpp v45, v33, v45 quad_perm:[1,1,1,1] row_mask:0xf bank_mask:0xf
    v_add_f32_dpp v46, v37, v46 quad_perm:[1,1,1,1] row_mask:0xf bank_mask:0xf
    v_add_f32_dpp v47, v41, v47 quad_perm:[1,1,1,1] row_mask:0xf bank_mask:0xf
    v_add_f32_dpp v44, v30, v44 quad_perm:[2,2,2,2] row_mask:0xf bank_mask:0xf
    v_add_f32_dpp v45, v34, v45 quad_perm:[2,2,2,2] row_mask:0xf bank_mask:0xf
    v_add_f32_dpp v46, v38, v46 quad_perm:[2,2,2,2] row_mask:0xf bank_mask:0xf
    v_add_f32_dpp v47, v42, v47 quad_perm:[2,2,2,2] row_mask:0xf bank_mask:0xf
    v_add_f32_dpp v44, v31, v44 quad_perm:[3,3,3,3] row_mask:0xf bank_mask:0xf
    v_add_f32_dpp v45, v35, v45 quad_perm:[3,3,3,3] row_mask:0xf bank_mask:0xf
    v_add_f32_dpp v46, v39, v46 quad_perm:[3,3,3,3] row_mask:0xf bank_mask:0xf
    v_add_f32_dpp v47, v43, v47 quad_perm:[3,3,3,3] row_mask:0xf bank_mask:0xf
    v_max3_f32 v22, v44, v45, v46
    v_max_f32 v22, v22, v47
    v_mul_f32 v22, s42, v22
    v_cmp_gt_f32 vcc, v22, v20
    s_cbranch_vccz L_keepp1
    s_call_b64 s[44:45], L_rescale
L_keepp1:
    v_fma_f32 v44, v44, s42, -v20
    v_fma_f32 v45, v45, s42, -v20
    v_fma_f32 v46, v46, s42, -v20
    v_fma_f32 v47, v47, s42, -v20
    v_exp_f32 v44, v44
    v_exp_f32 v45, v45
    v_exp_f32 v46, v46
    v_exp_f32 v47, v47
    v_cvt_pk_bf16_f32 v49, v44, v44
    v_cvt_pk_bf16_f32 v51, v45, v45
    v_cvt_pk_bf16_f32 v53, v46, v46
    v_cvt_pk_bf16_f32 v55, v47, v47
    v_add_f32 v44, v44, v45
    v_add_f32 v46, v46, v47
    v_and_b32 v48, v49, v4
    v_and_b32 v49, v49, v5
    v_and_b32 v50, v51, v4
    v_and_b32 v51, v51, v5
    v_and_b32 v52, v53, v4
    v_and_b32 v53, v53, v5
    v_and_b32 v54, v55, v4
    v_and_b32 v55, v55, v5
    v_add_f32 v21, v21, v44
    v_add_f32 v21, v21, v46
    v_mfma_f32_16x16x16_bf16 v[12:15], v[48:49], v[104:105], v[12:15]
    v_mfma_f32_16x16x16_bf16 v[16:19], v[48:49], v[106:107], v[16:19]
    v_mfma_f32_16x16x16_bf16 v[12:15], v[50:51], v[108:109], v[12:15]
    v_mfma_f32_16x16x16_bf16 v[16:19], v[50:51], v[110:111], v[16:19]
    v_mfma_f32_16x16x16_bf16 v[12:15], v[52:53], v[112:113], v[12:15]
    v_mfma_f32_16x16x16_bf16 v[16:19], v[52:53], v[114:115], v[16:19]
    v_mfma_f32_16x16x16_bf16 v[12:15], v[54:55], v[116:117], v[12:15]
    v_mfma_f32_16x16x16_bf16 v[16:19], v[54:55], v[118:119], v[16:19]
    s_waitcnt vmcnt(4)
    buffer_load_dwordx4 v[76:79], v3, s[28:31], s33 offen offset:1024 sc1 nt
    s_waitcnt vmcnt(4)
    buffer_load_dwordx4 v[80:83], v3, s[28:31], s33 offen offset:2048 sc1 nt
    s_branch L_stream3
L_helper2:
L_wo:
    s_waitcnt vmcnt(1)
    buffer_load_dwordx4 v2, s[24:27], s33 offen nt lds
    s_add_u32 m0, m0, 0x400
    s_add_u32 s33, s33, 0x2000
    s_cmp_lt_u32 s33, 131072
    s_cbranch_scc1 L_wo
    v_mul_u32_u24 v22, 4352, v1
    v_add_u32 v22, 851968, v22
    s_mov_b32 s49, 0
    s_mov_b32 exec_hi, 0
L_pollall:
    global_load_dword v24, v22, s[18:19] sc1
    s_add_u32 s49, s49, 1
    s_waitcnt vmcnt(0)
    v_and_b32 v25, 0x0f0f0f0f, v24
    v_lshrrev_b32 v26, 4, v24
    v_and_b32 v26, 0x0f0f0f0f, v26
    v_add_u32 v25, v25, v26
    v_sad_u8 v25, v25, 0, 0
    v_cmp_ne_u32 vcc, 8, v25
    s_cbranch_vccz L_gotall
    s_sleep 32
    s_cmp_lt_u32 s49, 100000
    s_cbranch_scc1 L_pollall
L_gotall:
    s_mov_b64 exec, -1
    v_mov_b32 v25, s59
    ds_write_b32 v5, v25 offset:25732
    s_cmp_eq_u32 s39, s22
    s_cselect_b32 s59, s59, 0
    s_and_b32 s41, s38, 3
    v_lshrrev_b32 v15, 2, v7
    v_lshlrev_b32 v15, 16, v15
    v_lshl_add_u32 v15, v14, 10, v15
    v_lshl_add_u32 v15, v6, 4, v15
    s_lshl_b32 s35, s22, 13
    s_lshl_b32 s50, s41, 8
    s_add_u32 s35, s35, s50
    s_add_u32 s35, s35, 262144
    v_add_u32 v15, s35, v15
    v_add_u32 v16, 0x1000, v15
    v_and_b32 v17, 7, v1
    v_lshlrev_b32 v17, 7, v17
    v_lshl_add_u32 v17, v6, 13, v17
    s_lshl_b32 s35, s22, 10
    s_lshl_b32 s50, s41, 3
    s_add_u32 s35, s35, s50
    s_add_u32 s35, s35, 524288
    v_add_u32 v17, s35, v17
    v_lshrrev_b32 v18, 1, v1
    v_lshlrev_b32 v18, 13, v18
    v_and_b32 v19, 1, v1
    v_lshl_add_u32 v18, v19, 4, v18
    s_lshl_b32 s35, s22, 10
    s_lshl_b32 s50, s21, 5
    s_add_u32 s35, s35, s50
    s_add_u32 s35, s35, 589824
    v_add_u32 v18, s35, v18
    v_and_b32 v19, 1, v6
    v_lshlrev_b32 v19, 6, v19
    v_lshrrev_b32 v20, 1, v6
    v_lshl_add_u32 v19, v20, 5, v19
    s_lshr_b32 s35, s21, 3
    s_lshl_b32 s35, s35, 10
    s_lshl_b32 s50, s22, 7
    s_add_u32 s35, s35, s50
    s_lshl_b32 s50, s55, 2
    s_add_u32 s35, s35, s50
    v_add_u32 v19, s35, v19
    ds_read_b64_tr_b16 v[32:33], v13 offset:0
    ds_read_b64_tr_b16 v[34:35], v13 offset:512
    ds_read_b64_tr_b16 v[36:37], v13 offset:32
    ds_read_b64_tr_b16 v[38:39], v13 offset:544
    ds_read_b64_tr_b16 v[40:41], v13 offset:64
    ds_read_b64_tr_b16 v[42:43], v13 offset:576
    ds_read_b64_tr_b16 v[44:45], v13 offset:96
    ds_read_b64_tr_b16 v[46:47], v13 offset:608
    s_waitcnt lgkmcnt(0)
    ds_read_b64_tr_b16 v[48:49], v13 offset:4096
    ds_read_b64_tr_b16 v[50:51], v13 offset:4608
    ds_read_b64_tr_b16 v[52:53], v13 offset:4128
    ds_read_b64_tr_b16 v[54:55], v13 offset:4640
    ds_read_b64_tr_b16 v[56:57], v13 offset:4160
    ds_read_b64_tr_b16 v[58:59], v13 offset:4672
    ds_read_b64_tr_b16 v[60:61], v13 offset:4192
    ds_read_b64_tr_b16 v[62:63], v13 offset:4704
    s_waitcnt lgkmcnt(0)
    ds_read_b64_tr_b16 v[64:65], v13 offset:8192
    ds_read_b64_tr_b16 v[66:67], v13 offset:8704
    ds_read_b64_tr_b16 v[68:69], v13 offset:8224
    ds_read_b64_tr_b16 v[70:71], v13 offset:8736
    ds_read_b64_tr_b16 v[72:73], v13 offset:8256
    ds_read_b64_tr_b16 v[74:75], v13 offset:8768
    ds_read_b64_tr_b16 v[76:77], v13 offset:8288
    ds_read_b64_tr_b16 v[78:79], v13 offset:8800
    s_waitcnt lgkmcnt(0)
    ds_read_b64_tr_b16 v[80:81], v13 offset:12288
    ds_read_b64_tr_b16 v[82:83], v13 offset:12800
    ds_read_b64_tr_b16 v[84:85], v13 offset:12320
    ds_read_b64_tr_b16 v[86:87], v13 offset:12832
    ds_read_b64_tr_b16 v[88:89], v13 offset:12352
    ds_read_b64_tr_b16 v[90:91], v13 offset:12864
    ds_read_b64_tr_b16 v[92:93], v13 offset:12384
    ds_read_b64_tr_b16 v[94:95], v13 offset:12896
    s_waitcnt lgkmcnt(0)
    s_mov_b32 s49, 0
    s_waitcnt lgkmcnt(0)
    s_branch L_helper3
L_stream3:
    v_mfma_f32_16x16x32_bf16 v[28:31], v[120:123], v[8:11], 0
    v_mfma_f32_16x16x32_bf16 v[32:35], v[124:127], v[8:11], 0
    v_mfma_f32_16x16x32_bf16 v[36:39], v[128:131], v[8:11], 0
    v_mfma_f32_16x16x32_bf16 v[40:43], v[132:135], v[8:11], 0
    s_waitcnt vmcnt(4)
    buffer_load_dwordx4 v[84:87], v3, s[28:31], s33 offen offset:3072 sc1 nt
    s_waitcnt vmcnt(4)
    s_add_u32 s33, s33, 0x20000
    s_and_b32 s33, s33, 0x3fffff
    buffer_load_dwordx4 v[88:91], v2, s[24:27], s33 offen offset:0 sc1 nt
    s_nop 5
    v_mov_b32_dpp v44, v28 quad_perm:[0,0,0,0] row_mask:0xf bank_mask:0xf
    v_mov_b32_dpp v45, v32 quad_perm:[0,0,0,0] row_mask:0xf bank_mask:0xf
    v_mov_b32_dpp v46, v36 quad_perm:[0,0,0,0] row_mask:0xf bank_mask:0xf
    v_mov_b32_dpp v47, v40 quad_perm:[0,0,0,0] row_mask:0xf bank_mask:0xf
    v_add_f32_dpp v44, v29, v44 quad_perm:[1,1,1,1] row_mask:0xf bank_mask:0xf
    v_add_f32_dpp v45, v33, v45 quad_perm:[1,1,1,1] row_mask:0xf bank_mask:0xf
    v_add_f32_dpp v46, v37, v46 quad_perm:[1,1,1,1] row_mask:0xf bank_mask:0xf
    v_add_f32_dpp v47, v41, v47 quad_perm:[1,1,1,1] row_mask:0xf bank_mask:0xf
    v_add_f32_dpp v44, v30, v44 quad_perm:[2,2,2,2] row_mask:0xf bank_mask:0xf
    v_add_f32_dpp v45, v34, v45 quad_perm:[2,2,2,2] row_mask:0xf bank_mask:0xf
    v_add_f32_dpp v46, v38, v46 quad_perm:[2,2,2,2] row_mask:0xf bank_mask:0xf
    v_add_f32_dpp v47, v42, v47 quad_perm:[2,2,2,2] row_mask:0xf bank_mask:0xf
    v_add_f32_dpp v44, v31, v44 quad_perm:[3,3,3,3] row_mask:0xf bank_mask:0xf
    v_add_f32_dpp v45, v35, v45 quad_perm:[3,3,3,3] row_mask:0xf bank_mask:0xf
    v_add_f32_dpp v46, v39, v46 quad_perm:[3,3,3,3] row_mask:0xf bank_mask:0xf
    v_add_f32_dpp v47, v43, v47 quad_perm:[3,3,3,3] row_mask:0xf bank_mask:0xf
    v_max3_f32 v22, v44, v45, v46
    v_max_f32 v22, v22, v47
    v_mul_f32 v22, s42, v22
    v_cmp_gt_f32 vcc, v22, v20
    s_cbranch_vccz L_keepp2
    s_call_b64 s[44:45], L_rescale
L_keepp2:
    v_fma_f32 v44, v44, s42, -v20
    v_fma_f32 v45, v45, s42, -v20
    v_fma_f32 v46, v46, s42, -v20
    v_fma_f32 v47, v47, s42, -v20
    v_exp_f32 v44, v44
    v_exp_f32 v45, v45
    v_exp_f32 v46, v46
    v_exp_f32 v47, v47
    v_cvt_pk_bf16_f32 v49, v44, v44
    v_cvt_pk_bf16_f32 v51, v45, v45
    v_cvt_pk_bf16_f32 v53, v46, v46
    v_cvt_pk_bf16_f32 v55, v47, v47
    v_add_f32 v44, v44, v45
    v_add_f32 v46, v46, v47
    v_and_b32 v48, v49, v4
    v_and_b32 v49, v49, v5
    v_and_b32 v50, v51, v4
    v_and_b32 v51, v51, v5
    v_and_b32 v52, v53, v4
    v_and_b32 v53, v53, v5
    v_and_b32 v54, v55, v4
    v_and_b32 v55, v55, v5
    v_add_f32 v21, v21, v44
    v_add_f32 v21, v21, v46
    v_mfma_f32_16x16x16_bf16 v[12:15], v[48:49], v[136:137], v[12:15]
    v_mfma_f32_16x16x16_bf16 v[16:19], v[48:49], v[138:139], v[16:19]
    v_mfma_f32_16x16x16_bf16 v[12:15], v[50:51], v[140:141], v[12:15]
    v_mfma_f32_16x16x16_bf16 v[16:19], v[50:51], v[142:143], v[16:19]
    v_mfma_f32_16x16x16_bf16 v[12:15], v[52:53], v[144:145], v[12:15]
    v_mfma_f32_16x16x16_bf16 v[16:19], v[52:53], v[146:147], v[16:19]
    v_mfma_f32_16x16x16_bf16 v[12:15], v[54:55], v[148:149], v[12:15]
    v_mfma_f32_16x16x16_bf16 v[16:19], v[54:55], v[150:151], v[16:19]
    s_waitcnt vmcnt(4)
    buffer_load_dwordx4 v[92:95], v2, s[24:27], s33 offen offset:1024 sc1 nt
    v_mfma_f32_16x16x32_bf16 v[28:31], v[152:155], v[8:11], 0
    v_mfma_f32_16x16x32_bf16 v[32:35], v[156:159], v[8:11], 0
    v_mfma_f32_16x16x32_bf16 v[36:39], v[160:163], v[8:11], 0
    v_mfma_f32_16x16x32_bf16 v[40:43], v[164:167], v[8:11], 0
    s_waitcnt vmcnt(4)
    buffer_load_dwordx4 v[96:99], v2, s[24:27], s33 offen offset:2048 sc1 nt
    s_waitcnt vmcnt(4)
    buffer_load_dwordx4 v[100:103], v2, s[24:27], s33 offen offset:3072 sc1 nt
    s_nop 5
    v_mov_b32_dpp v44, v28 quad_perm:[0,0,0,0] row_mask:0xf bank_mask:0xf
    v_mov_b32_dpp v45, v32 quad_perm:[0,0,0,0] row_mask:0xf bank_mask:0xf
    v_mov_b32_dpp v46, v36 quad_perm:[0,0,0,0] row_mask:0xf bank_mask:0xf
    v_mov_b32_dpp v47, v40 quad_perm:[0,0,0,0] row_mask:0xf bank_mask:0xf
    v_add_f32_dpp v44, v29, v44 quad_perm:[1,1,1,1] row_mask:0xf bank_mask:0xf
    v_add_f32_dpp v45, v33, v45 quad_perm:[1,1,1,1] row_mask:0xf bank_mask:0xf
    v_add_f32_dpp v46, v37, v46 quad_perm:[1,1,1,1] row_mask:0xf bank_mask:0xf
    v_add_f32_dpp v47, v41, v47 quad_perm:[1,1,1,1] row_mask:0xf bank_mask:0xf
    v_add_f32_dpp v44, v30, v44 quad_perm:[2,2,2,2] row_mask:0xf bank_mask:0xf
    v_add_f32_dpp v45, v34, v45 quad_perm:[2,2,2,2] row_mask:0xf bank_mask:0xf
    v_add_f32_dpp v46, v38, v46 quad_perm:[2,2,2,2] row_mask:0xf bank_mask:0xf
    v_add_f32_dpp v47, v42, v47 quad_perm:[2,2,2,2] row_mask:0xf bank_mask:0xf
    v_add_f32_dpp v44, v31, v44 quad_perm:[3,3,3,3] row_mask:0xf bank_mask:0xf
    v_add_f32_dpp v45, v35, v45 quad_perm:[3,3,3,3] row_mask:0xf bank_mask:0xf
    v_add_f32_dpp v46, v39, v46 quad_perm:[3,3,3,3] row_mask:0xf bank_mask:0xf
    v_add_f32_dpp v47, v43, v47 quad_perm:[3,3,3,3] row_mask:0xf bank_mask:0xf
    v_max3_f32 v22, v44, v45, v46
    v_max_f32 v22, v22, v47
    v_mul_f32 v22, s42, v22
    v_cmp_gt_f32 vcc, v22, v20
    s_cbranch_vccz L_keepp3
    s_call_b64 s[44:45], L_rescale
L_keepp3:
    v_fma_f32 v44, v44, s42, -v20
    v_fma_f32 v45, v45, s42, -v20
    v_fma_f32 v46, v46, s42, -v20
    v_fma_f32 v47, v47, s42, -v20
    v_exp_f32 v44, v44
    v_exp_f32 v45, v45
    v_exp_f32 v46, v46
    v_exp_f32 v47, v47
    v_cvt_pk_bf16_f32 v49, v44, v44
    v_cvt_pk_bf16_f32 v51, v45, v45
    v_cvt_pk_bf16_f32 v53, v46, v46
    v_cvt_pk_bf16_f32 v55, v47, v47
    v_add_f32 v44, v44, v45
    v_add_f32 v46, v46, v47
    v_and_b32 v48, v49, v4
    v_and_b32 v49, v49, v5
    v_and_b32 v50, v51, v4
    v_and_b32 v51, v51, v5
    v_and_b32 v52, v53, v4
    v_and_b32 v53, v53, v5
    v_and_b32 v54, v55, v4
    v_and_b32 v55, v55, v5
    v_add_f32 v21, v21, v44
    v_add_f32 v21, v21, v46
    v_mfma_f32_16x16x16_bf16 v[12:15], v[48:49], v[168:169], v[12:15]
    v_mfma_f32_16x16x16_bf16 v[16:19], v[48:49], v[170:171], v[16:19]
    v_mfma_f32_16x16x16_bf16 v[12:15], v[50:51], v[172:173], v[12:15]
    v_mfma_f32_16x16x16_bf16 v[16:19], v[50:51], v[174:175], v[16:19]
    v_mfma_f32_16x16x16_bf16 v[12:15], v[52:53], v[176:177], v[12:15]
    v_mfma_f32_16x16x16_bf16 v[16:19], v[52:53], v[178:179], v[16:19]
    v_mfma_f32_16x16x16_bf16 v[12:15], v[54:55], v[180:181], v[12:15]
    v_mfma_f32_16x16x16_bf16 v[16:19], v[54:55], v[182:183], v[16:19]
    s_waitcnt vmcnt(4)
    buffer_load_dwordx4 v[104:107], v3, s[28:31], s33 offen offset:0 sc1 nt
    v_mfma_f32_16x16x32_bf16 v[28:31], v[184:187], v[8:11], 0
    v_mfma_f32_16x16x32_bf16 v[32:35], v[188:191], v[8:11], 0
    v_mfma_f32_16x16x32_bf16 v[36:39], v[192:195], v[8:11], 0
    v_mfma_f32_16x16x32_bf16 v[40:43], v[196:199], v[8:11], 0
    s_waitcnt vmcnt(4)
    buffer_load_dwordx4 v[108:111], v3, s[28:31], s33 offen offset:1024 sc1 nt
    s_waitcnt vmcnt(4)
    buffer_load_dwordx4 v[112:115], v3, s[28:31], s33 offen offset:2048 sc1 nt
    s_nop 5
    v_mov_b32_dpp v44, v28 quad_perm:[0,0,0,0] row_mask:0xf bank_mask:0xf
    v_mov_b32_dpp v45, v32 quad_perm:[0,0,0,0] row_mask:0xf bank_mask:0xf
    v_mov_b32_dpp v46, v36 quad_perm:[0,0,0,0] row_mask:0xf bank_mask:0xf
    v_mov_b32_dpp v47, v40 quad_perm:[0,0,0,0] row_mask:0xf bank_mask:0xf
    v_add_f32_dpp v44, v29, v44 quad_perm:[1,1,1,1] row_mask:0xf bank_mask:0xf
    v_add_f32_dpp v45, v33, v45 quad_perm:[1,1,1,1] row_mask:0xf bank_mask:0xf
    v_add_f32_dpp v46, v37, v46 quad_perm:[1,1,1,1] row_mask:0xf bank_mask:0xf
    v_add_f32_dpp v47, v41, v47 quad_perm:[1,1,1,1] row_mask:0xf bank_mask:0xf
    v_add_f32_dpp v44, v30, v44 quad_perm:[2,2,2,2] row_mask:0xf bank_mask:0xf
    v_add_f32_dpp v45, v34, v45 quad_perm:[2,2,2,2] row_mask:0xf bank_mask:0xf
    v_add_f32_dpp v46, v38, v46 quad_perm:[2,2,2,2] row_mask:0xf bank_mask:0xf
    v_add_f32_dpp v47, v42, v47 quad_perm:[2,2,2,2] row_mask:0xf bank_mask:0xf
    v_add_f32_dpp v44, v31, v44 quad_perm:[3,3,3,3] row_mask:0xf bank_mask:0xf
    v_add_f32_dpp v45, v35, v45 quad_perm:[3,3,3,3] row_mask:0xf bank_mask:0xf
    v_add_f32_dpp v46, v39, v46 quad_perm:[3,3,3,3] row_mask:0xf bank_mask:0xf
    v_add_f32_dpp v47, v43, v47 quad_perm:[3,3,3,3] row_mask:0xf bank_mask:0xf
    v_max3_f32 v22, v44, v45, v46
    v_max_f32 v22, v22, v47
    v_mul_f32 v22, s42, v22
    v_cmp_gt_f32 vcc, v22, v20
    s_cbranch_vccz L_keepp4
    s_call_b64 s[44:45], L_rescale
L_keepp4:
    v_fma_f32 v44, v44, s42, -v20
    v_fma_f32 v45, v45, s42, -v20
    v_fma_f32 v46, v46, s42, -v20
    v_fma_f32 v47, v47, s42, -v20
    v_exp_f32 v44, v44
    v_exp_f32 v45, v45
    v_exp_f32 v46, v46
    v_exp_f32 v47, v47
    v_cvt_pk_bf16_f32 v49, v44, v44
    v_cvt_pk_bf16_f32 v51, v45, v45
    v_cvt_pk_bf16_f32 v53, v46, v46
    v_cvt_pk_bf16_f32 v55, v47, v47
    v_add_f32 v44, v44, v45
    v_add_f32 v46, v46, v47
    v_and_b32 v48, v49, v4
    v_and_b32 v49, v49, v5
    v_and_b32 v50, v51, v4
    v_and_b32 v51, v51, v5
    v_and_b32 v52, v53, v4
    v_and_b32 v53, v53, v5
    v_and_b32 v54, v55, v4
    v_and_b32 v55, v55, v5
    v_add_f32 v21, v21, v44
    v_add_f32 v21, v21, v46
    v_mfma_f32_16x16x16_bf16 v[12:15], v[48:49], v[200:201], v[12:15]
    v_mfma_f32_16x16x16_bf16 v[16:19], v[48:49], v[202:203], v[16:19]
    v_mfma_f32_16x16x16_bf16 v[12:15], v[50:51], v[204:205], v[12:15]
    v_mfma_f32_16x16x16_bf16 v[16:19], v[50:51], v[206:207], v[16:19]
    v_mfma_f32_16x16x16_bf16 v[12:15], v[52:53], v[208:209], v[12:15]
    v_mfma_f32_16x16x16_bf16 v[16:19], v[52:53], v[210:211], v[16:19]
    v_mfma_f32_16x16x16_bf16 v[12:15], v[54:55], v[212:213], v[12:15]
    v_mfma_f32_16x16x16_bf16 v[16:19], v[54:55], v[214:215], v[16:19]
    s_waitcnt vmcnt(4)
    buffer_load_dwordx4 v[116:119], v3, s[28:31], s33 offen offset:3072 sc1 nt
    s_waitcnt vmcnt(4)
    s_add_u32 s33, s33, 0x20000
    s_and_b32 s33, s33, 0x3fffff
    buffer_load_dwordx4 v[120:123], v2, s[24:27], s33 offen offset:0 sc1 nt
    v_mfma_f32_16x16x32_bf16 v[28:31], v[216:219], v[8:11], 0
    v_mfma_f32_16x16x32_bf16 v[32:35], v[220:223], v[8:11], 0
    v_mfma_f32_16x16x32_bf16 v[36:39], v[224:227], v[8:11], 0
    v_mfma_f32_16x16x32_bf16 v[40:43], v[228:231], v[8:11], 0
    s_waitcnt vmcnt(4)
    buffer_load_dwordx4 v[124:127], v2, s[24:27], s33 offen offset:1024 sc1 nt
    s_nop 5
    v_mov_b32_dpp v44, v28 quad_perm:[0,0,0,0] row_mask:0xf bank_mask:0xf
    v_mov_b32_dpp v45, v32 quad_perm:[0,0,0,0] row_mask:0xf bank_mask:0xf
    v_mov_b32_dpp v46, v36 quad_perm:[0,0,0,0] row_mask:0xf bank_mask:0xf
    v_mov_b32_dpp v47, v40 quad_perm:[0,0,0,0] row_mask:0xf bank_mask:0xf
    v_add_f32_dpp v44, v29, v44 quad_perm:[1,1,1,1] row_mask:0xf bank_mask:0xf
    v_add_f32_dpp v45, v33, v45 quad_perm:[1,1,1,1] row_mask:0xf bank_mask:0xf
    v_add_f32_dpp v46, v37, v46 quad_perm:[1,1,1,1] row_mask:0xf bank_mask:0xf
    v_add_f32_dpp v47, v41, v47 quad_perm:[1,1,1,1] row_mask:0xf bank_mask:0xf
    v_add_f32_dpp v44, v30, v44 quad_perm:[2,2,2,2] row_mask:0xf bank_mask:0xf
    v_add_f32_dpp v45, v34, v45 quad_perm:[2,2,2,2] row_mask:0xf bank_mask:0xf
    v_add_f32_dpp v46, v38, v46 quad_perm:[2,2,2,2] row_mask:0xf bank_mask:0xf
    v_add_f32_dpp v47, v42, v47 quad_perm:[2,2,2,2] row_mask:0xf bank_mask:0xf
    v_add_f32_dpp v44, v31, v44 quad_perm:[3,3,3,3] row_mask:0xf bank_mask:0xf
    v_add_f32_dpp v45, v35, v45 quad_perm:[3,3,3,3] row_mask:0xf bank_mask:0xf
    v_add_f32_dpp v46, v39, v46 quad_perm:[3,3,3,3] row_mask:0xf bank_mask:0xf
    v_add_f32_dpp v47, v43, v47 quad_perm:[3,3,3,3] row_mask:0xf bank_mask:0xf
    v_max3_f32 v22, v44, v45, v46
    v_max_f32 v22, v22, v47
    v_mul_f32 v22, s42, v22
    v_cmp_gt_f32 vcc, v22, v20
    s_cbranch_vccz L_keepp5
    s_call_b64 s[44:45], L_rescale
L_keepp5:
    v_fma_f32 v44, v44, s42, -v20
    v_fma_f32 v45, v45, s42, -v20
    v_fma_f32 v46, v46, s42, -v20
    v_fma_f32 v47, v47, s42, -v20
    v_exp_f32 v44, v44
    v_exp_f32 v45, v45
    v_exp_f32 v46, v46
    v_exp_f32 v47, v47
    v_cvt_pk_bf16_f32 v49, v44, v44
    v_cvt_pk_bf16_f32 v51, v45, v45
    v_cvt_pk_bf16_f32 v53, v46, v46
    v_cvt_pk_bf16_f32 v55, v47, v47
    v_add_f32 v44, v44, v45
    v_add_f32 v46, v46, v47
    v_and_b32 v48, v49, v4
    v_and_b32 v49, v49, v5
    v_and_b32 v50, v51, v4
    v_and_b32 v51, v51, v5
    v_and_b32 v52, v53, v4
    v_and_b32 v53, v53, v5
    v_and_b32 v54, v55, v4
    v_and_b32 v55, v55, v5
    v_add_f32 v21, v21, v44
    v_add_f32 v21, v21, v46
    v_mfma_f32_16x16x16_bf16 v[12:15], v[48:49], v[232:233], v[12:15]
    v_mfma_f32_16x16x16_bf16 v[16:19], v[48:49], v[234:235], v[16:19]
    v_mfma_f32_16x16x16_bf16 v[12:15], v[50:51], v[236:237], v[12:15]
    v_mfma_f32_16x16x16_bf16 v[16:19], v[50:51], v[238:239], v[16:19]
    v_mfma_f32_16x16x16_bf16 v[12:15], v[52:53], v[240:241], v[12:15]
    v_mfma_f32_16x16x16_bf16 v[16:19], v[52:53], v[242:243], v[16:19]
    v_mfma_f32_16x16x16_bf16 v[12:15], v[54:55], v[244:245], v[12:15]
    v_mfma_f32_16x16x16_bf16 v[16:19], v[54:55], v[246:247], v[16:19]
    s_waitcnt vmcnt(4)
    buffer_load_dwordx4 v[128:131], v2, s[24:27], s33 offen offset:2048 sc1 nt
    s_waitcnt vmcnt(4)
    buffer_load_dwordx4 v[132:135], v2, s[24:27], s33 offen offset:3072 sc1 nt
    v_mfma_f32_16x16x32_bf16 v[28:31], v[56:59], v[8:11], 0
    v_mfma_f32_16x16x32_bf16 v[32:35], v[60:63], v[8:11], 0
    v_mfma_f32_16x16x32_bf16 v[36:39], v[64:67], v[8:11], 0
    v_mfma_f32_16x16x32_bf16 v[40:43], v[68:71], v[8:11], 0
    s_waitcnt vmcnt(4)
    buffer_load_dwordx4 v[136:139], v3, s[28:31], s33 offen offset:0 sc1 nt
    s_nop 5
    v_mov_b32_dpp v44, v28 quad_perm:[0,0,0,0] row_mask:0xf bank_mask:0xf
    v_mov_b32_dpp v45, v32 quad_perm:[0,0,0,0] row_mask:0xf bank_mask:0xf
    v_mov_b32_dpp v46, v36 quad_perm:[0,0,0,0] row_mask:0xf bank_mask:0xf
    v_mov_b32_dpp v47, v40 quad_perm:[0,0,0,0] row_mask:0xf bank_mask:0xf
    v_add_f32_dpp v44, v29, v44 quad_perm:[1,1,1,1] row_mask:0xf bank_mask:0xf
    v_add_f32_dpp v45, v33, v45 quad_perm:[1,1,1,1] row_mask:0xf bank_mask:0xf
    v_add_f32_dpp v46, v37, v46 quad_perm:[1,1,1,1] row_mask:0xf bank_mask:0xf
    v_add_f32_dpp v47, v41, v47 quad_perm:[1,1,1,1] row_mask:0xf bank_mask:0xf
    v_add_f32_dpp v44, v30, v44 quad_perm:[2,2,2,2] row_mask:0xf bank_mask:0xf
    v_add_f32_dpp v45, v34, v45 quad_perm:[2,2,2,2] row_mask:0xf bank_mask:0xf
    v_add_f32_dpp v46, v38, v46 quad_perm:[2,2,2,2] row_mask:0xf bank_mask:0xf
    v_add_f32_dpp v47, v42, v47 quad_perm:[2,2,2,2] row_mask:0xf bank_mask:0xf
    v_add_f32_dpp v44, v31, v44 quad_perm:[3,3,3,3] row_mask:0xf bank_mask:0xf
    v_add_f32_dpp v45, v35, v45 quad_perm:[3,3,3,3] row_mask:0xf bank_mask:0xf
    v_add_f32_dpp v46, v39, v46 quad_perm:[3,3,3,3] row_mask:0xf bank_mask:0xf
    v_add_f32_dpp v47, v43, v47 quad_perm:[3,3,3,3] row_mask:0xf bank_mask:0xf
    v_max3_f32 v22, v44, v45, v46
    v_max_f32 v22, v22, v47
    v_mul_f32 v22, s42, v22
    v_cmp_gt_f32 vcc, v22, v20
    s_cbranch_vccz L_keepp6
    s_call_b64 s[44:45], L_rescale
L_keepp6:
    v_fma_f32 v44, v44, s42, -v20
    v_fma_f32 v45, v45, s42, -v20
    v_fma_f32 v46, v46, s42, -v20
    v_fma_f32 v47, v47, s42, -v20
    v_exp_f32 v44, v44
    v_exp_f32 v45, v45
    v_exp_f32 v46, v46
    v_exp_f32 v47, v47
    v_cvt_pk_bf16_f32 v49, v44, v44
    v_cvt_pk_bf16_f32 v51, v45, v45
    v_cvt_pk_bf16_f32 v53, v46, v46
    v_cvt_pk_bf16_f32 v55, v47, v47
    v_add_f32 v44, v44, v45
    v_add_f32 v46, v46, v47
    v_and_b32 v48, v49, v4
    v_and_b32 v49, v49, v5
    v_and_b32 v50, v51, v4
    v_and_b32 v51, v51, v5
    v_and_b32 v52, v53, v4
    v_and_b32 v53, v53, v5
    v_and_b32 v54, v55, v4
    v_and_b32 v55, v55, v5
    v_add_f32 v21, v21, v44
    v_add_f32 v21, v21, v46
    v_mfma_f32_16x16x16_bf16 v[12:15], v[48:49], v[72:73], v[12:15]
    v_mfma_f32_16x16x16_bf16 v[16:19], v[48:49], v[74:75], v[16:19]
    v_mfma_f32_16x16x16_bf16 v[12:15], v[50:51], v[76:77], v[12:15]
    v_mfma_f32_16x16x16_bf16 v[16:19], v[50:51], v[78:79], v[16:19]
    v_mfma_f32_16x16x16_bf16 v[12:15], v[52:53], v[80:81], v[12:15]
    v_mfma_f32_16x16x16_bf16 v[16:19], v[52:53], v[82:83], v[16:19]
    v_mfma_f32_16x16x16_bf16 v[12:15], v[54:55], v[84:85], v[12:15]
    v_mfma_f32_16x16x16_bf16 v[16:19], v[54:55], v[86:87], v[16:19]
    s_waitcnt vmcnt(4)
    buffer_load_dwordx4 v[140:143], v3, s[28:31], s33 offen offset:1024 sc1 nt
    s_waitcnt vmcnt(4)
    buffer_load_dwordx4 v[144:147], v3, s[28:31], s33 offen offset:2048 sc1 nt
    v_mfma_f32_16x16x32_bf16 v[28:31], v[88:91], v[8:11], 0
    v_mfma_f32_16x16x32_bf16 v[32:35], v[92:95], v[8:11], 0
    v_mfma_f32_16x16x32_bf16 v[36:39], v[96:99], v[8:11], 0
    v_mfma_f32_16x16x32_bf16 v[40:43], v[100:103], v[8:11], 0
    s_waitcnt vmcnt(4)
    buffer_load_dwordx4 v[148:151], v3, s[28:31], s33 offen offset:3072 sc1 nt
    s_waitcnt vmcnt(4)
    s_add_u32 s33, s33, 0x20000
    s_and_b32 s33, s33, 0x3fffff
    buffer_load_dwordx4 v[152:155], v2, s[24:27], s33 offen offset:0 sc1 nt
    s_nop 5
    v_mov_b32_dpp v44, v28 quad_perm:[0,0,0,0] row_mask:0xf bank_mask:0xf
    v_mov_b32_dpp v45, v32 quad_perm:[0,0,0,0] row_mask:0xf bank_mask:0xf
    v_mov_b32_dpp v46, v36 quad_perm:[0,0,0,0] row_mask:0xf bank_mask:0xf
    v_mov_b32_dpp v47, v40 quad_perm:[0,0,0,0] row_mask:0xf bank_mask:0xf
    v_add_f32_dpp v44, v29, v44 quad_perm:[1,1,1,1] row_mask:0xf bank_mask:0xf
    v_add_f32_dpp v45, v33, v45 quad_perm:[1,1,1,1] row_mask:0xf bank_mask:0xf
    v_add_f32_dpp v46, v37, v46 quad_perm:[1,1,1,1] row_mask:0xf bank_mask:0xf
    v_add_f32_dpp v47, v41, v47 quad_perm:[1,1,1,1] row_mask:0xf bank_mask:0xf
    v_add_f32_dpp v44, v30, v44 quad_perm:[2,2,2,2] row_mask:0xf bank_mask:0xf
    v_add_f32_dpp v45, v34, v45 quad_perm:[2,2,2,2] row_mask:0xf bank_mask:0xf
    v_add_f32_dpp v46, v38, v46 quad_perm:[2,2,2,2] row_mask:0xf bank_mask:0xf
    v_add_f32_dpp v47, v42, v47 quad_perm:[2,2,2,2] row_mask:0xf bank_mask:0xf
    v_add_f32_dpp v44, v31, v44 quad_perm:[3,3,3,3] row_mask:0xf bank_mask:0xf
    v_add_f32_dpp v45, v35, v45 quad_perm:[3,3,3,3] row_mask:0xf bank_mask:0xf
    v_add_f32_dpp v46, v39, v46 quad_perm:[3,3,3,3] row_mask:0xf bank_mask:0xf
    v_add_f32_dpp v47, v43, v47 quad_perm:[3,3,3,3] row_mask:0xf bank_mask:0xf
    v_max3_f32 v22, v44, v45, v46
    v_max_f32 v22, v22, v47
    v_mul_f32 v22, s42, v22
    v_cmp_gt_f32 vcc, v22, v20
    s_cbranch_vccz L_keepp7
    s_call_b64 s[44:45], L_rescale
L_keepp7:
    v_fma_f32 v44, v44, s42, -v20
    v_fma_f32 v45, v45, s42, -v20
    v_fma_f32 v46, v46, s42, -v20
    v_fma_f32 v47, v47, s42, -v20
    v_exp_f32 v44, v44
    v_exp_f32 v45, v45
    v_exp_f32 v46, v46
    v_exp_f32 v47, v47
    v_cvt_pk_bf16_f32 v49, v44, v44
    v_cvt_pk_bf16_f32 v51, v45, v45
    v_cvt_pk_bf16_f32 v53, v46, v46
    v_cvt_pk_bf16_f32 v55, v47, v47
    v_add_f32 v44, v44, v45
    v_add_f32 v46, v46, v47
    v_and_b32 v48, v49, v4
    v_and_b32 v49, v49, v5
    v_and_b32 v50, v51, v4
    v_and_b32 v51, v51, v5
    v_and_b32 v52, v53, v4
    v_and_b32 v53, v53, v5
    v_and_b32 v54, v55, v4
    v_and_b32 v55, v55, v5
    v_add_f32 v21, v21, v44
    v_add_f32 v21, v21, v46
    v_mfma_f32_16x16x16_bf16 v[12:15], v[48:49], v[104:105], v[12:15]
    v_mfma_f32_16x16x16_bf16 v[16:19], v[48:49], v[106:107], v[16:19]
    v_mfma_f32_16x16x16_bf16 v[12:15], v[50:51], v[108:109], v[12:15]
    v_mfma_f32_16x16x16_bf16 v[16:19], v[50:51], v[110:111], v[16:19]
    v_mfma_f32_16x16x16_bf16 v[12:15], v[52:53], v[112:113], v[12:15]
    v_mfma_f32_16x16x16_bf16 v[16:19], v[52:53], v[114:115], v[16:19]
    v_mfma_f32_16x16x16_bf16 v[12:15], v[54:55], v[116:117], v[12:15]
    v_mfma_f32_16x16x16_bf16 v[16:19], v[54:55], v[118:119], v[16:19]
    s_waitcnt vmcnt(4)
    buffer_load_dwordx4 v[156:159], v2, s[24:27], s33 offen offset:1024 sc1 nt
    v_mfma_f32_16x16x32_bf16 v[28:31], v[120:123], v[8:11], 0
    v_mfma_f32_16x16x32_bf16 v[32:35], v[124:127], v[8:11], 0
    v_mfma_f32_16x16x32_bf16 v[36:39], v[128:131], v[8:11], 0
    v_mfma_f32_16x16x32_bf16 v[40:43], v[132:135], v[8:11], 0
    s_waitcnt vmcnt(4)
    buffer_load_dwordx4 v[160:163], v2, s[24:27], s33 offen offset:2048 sc1 nt
    s_waitcnt vmcnt(4)
    buffer_load_dwordx4 v[164:167], v2, s[24:27], s33 offen offset:3072 sc1 nt
    s_nop 5
    v_mov_b32_dpp v44, v28 quad_perm:[0,0,0,0] row_mask:0xf bank_mask:0xf
    v_mov_b32_dpp v45, v32 quad_perm:[0,0,0,0] row_mask:0xf bank_mask:0xf
    v_mov_b32_dpp v46, v36 quad_perm:[0,0,0,0] row_mask:0xf bank_mask:0xf
    v_mov_b32_dpp v47, v40 quad_perm:[0,0,0,0] row_mask:0xf bank_mask:0xf
    v_add_f32_dpp v44, v29, v44 quad_perm:[1,1,1,1] row_mask:0xf bank_mask:0xf
    v_add_f32_dpp v45, v33, v45 quad_perm:[1,1,1,1] row_mask:0xf bank_mask:0xf
    v_add_f32_dpp v46, v37, v46 quad_perm:[1,1,1,1] row_mask:0xf bank_mask:0xf
    v_add_f32_dpp v47, v41, v47 quad_perm:[1,1,1,1] row_mask:0xf bank_mask:0xf
    v_add_f32_dpp v44, v30, v44 quad_perm:[2,2,2,2] row_mask:0xf bank_mask:0xf
    v_add_f32_dpp v45, v34, v45 quad_perm:[2,2,2,2] row_mask:0xf bank_mask:0xf
    v_add_f32_dpp v46, v38, v46 quad_perm:[2,2,2,2] row_mask:0xf bank_mask:0xf
    v_add_f32_dpp v47, v42, v47 quad_perm:[2,2,2,2] row_mask:0xf bank_mask:0xf
    v_add_f32_dpp v44, v31, v44 quad_perm:[3,3,3,3] row_mask:0xf bank_mask:0xf
    v_add_f32_dpp v45, v35, v45 quad_perm:[3,3,3,3] row_mask:0xf bank_mask:0xf
    v_add_f32_dpp v46, v39, v46 quad_perm:[3,3,3,3] row_mask:0xf bank_mask:0xf
    v_add_f32_dpp v47, v43, v47 quad_perm:[3,3,3,3] row_mask:0xf bank_mask:0xf
    v_max3_f32 v22, v44, v45, v46
    v_max_f32 v22, v22, v47
    v_mul_f32 v22, s42, v22
    v_cmp_gt_f32 vcc, v22, v20
    s_cbranch_vccz L_keepp8
    s_call_b64 s[44:45], L_rescale
L_keepp8:
    v_fma_f32 v44, v44, s42, -v20
    v_fma_f32 v45, v45, s42, -v20
    v_fma_f32 v46, v46, s42, -v20
    v_fma_f32 v47, v47, s42, -v20
    v_exp_f32 v44, v44
    v_exp_f32 v45, v45
    v_exp_f32 v46, v46
    v_exp_f32 v47, v47
    v_cvt_pk_bf16_f32 v49, v44, v44
    v_cvt_pk_bf16_f32 v51, v45, v45
    v_cvt_pk_bf16_f32 v53, v46, v46
    v_cvt_pk_bf16_f32 v55, v47, v47
    v_add_f32 v44, v44, v45
    v_add_f32 v46, v46, v47
    v_and_b32 v48, v49, v4
    v_and_b32 v49, v49, v5
    v_and_b32 v50, v51, v4
    v_and_b32 v51, v51, v5
    v_and_b32 v52, v53, v4
    v_and_b32 v53, v53, v5
    v_and_b32 v54, v55, v4
    v_and_b32 v55, v55, v5
    v_add_f32 v21, v21, v44
    v_add_f32 v21, v21, v46
    v_mfma_f32_16x16x16_bf16 v[12:15], v[48:49], v[136:137], v[12:15]
    v_mfma_f32_16x16x16_bf16 v[16:19], v[48:49], v[138:139], v[16:19]
    v_mfma_f32_16x16x16_bf16 v[12:15], v[50:51], v[140:141], v[12:15]
    v_mfma_f32_16x16x16_bf16 v[16:19], v[50:51], v[142:143], v[16:19]
    v_mfma_f32_16x16x16_bf16 v[12:15], v[52:53], v[144:145], v[12:15]
    v_mfma_f32_16x16x16_bf16 v[16:19], v[52:53], v[146:147], v[16:19]
    s_waitcnt vmcnt(4)
    v_mfma_f32_16x16x16_bf16 v[12:15], v[54:55], v[148:149], v[12:15]
    v_mfma_f32_16x16x16_bf16 v[16:19], v[54:55], v[150:151], v[16:19]
    buffer_load_dwordx4 v[168:171], v3, s[28:31], s33 offen offset:0 sc1 nt
    s_mov_b32 s43, 23
    s_mov_b32 s52, 16
    s_mov_b32 s53, 0x701c00
    s_mov_b32 s46, 0
    s_mov_b32 s41, 288
    s_mul_i32 s35, s21, 4352
    s_add_u32 s35, s35, 851968
    s_add_u32 s48, s18, s35
    s_addc_u32 s49, s19, 0
    s_mov_b32 s84, 0x1000
    s_mov_b32 s85, 0x100000
    s_mov_b32 s86, 0x490011
    s_mov_b32 s87, 0xff006d
L_loop:
    s_bitcmp1_b32 s52, 0
    s_cbranch_scc1 L_loop_w0
    s_bitcmp0_b32 s52, 8
    s_cbranch_scc1 L_loop_v0
    s_waitcnt vmcnt(3)
L_loop_v0:
    s_waitcnt vmcnt(4)
L_loop_w0:
    buffer_load_dwordx4 v[172:175], v3, s[28:31], s33 offen offset:1024 sc1 nt
    s_waitcnt vmcnt(5)
    v_mfma_f32_16x16x32_bf16 v[28:31], v[152:155], v[8:11], 0
    s_bitcmp1_b32 s52, 1
    s_cbranch_scc1 L_loop_w1
    s_waitcnt vmcnt(4)
L_loop_w1:
    buffer_load_dwordx4 v[176:179], v3, s[28:31], s33 offen offset:2048 sc1 nt
    s_waitcnt vmcnt(5)
    v_mfma_f32_16x16x32_bf16 v[32:35], v[156:159], v[8:11], 0
    s_bitcmp1_b32 s52, 2
    s_cbranch_scc1 L_loop_w2
    s_waitcnt vmcnt(4)
L_loop_w2:
    buffer_load_dwordx4 v[180:183], v3, s[28:31], s33 offen offset:3072 sc1 nt
    s_waitcnt vmcnt(5)
    v_mfma_f32_16x16x32_bf16 v[36:39], v[160:163], v[8:11], 0
    s_nop 3
    v_mov_b32_dpp v44, v28 quad_perm:[0,0,0,0] row_mask:0xf bank_mask:0xf
    v_mov_b32_dpp v45, v32 quad_perm:[0,0,0,0] row_mask:0xf bank_mask:0xf
    s_nop 0
    v_add_f32_dpp v44, v29, v44 quad_perm:[1,1,1,1] row_mask:0xf bank_mask:0xf
    v_add_f32_dpp v45, v33, v45 quad_perm:[1,1,1,1] row_mask:0xf bank_mask:0xf
    s_nop 0
    v_add_f32_dpp v44, v30, v44 quad_perm:[2,2,2,2] row_mask:0xf bank_mask:0xf
    v_add_f32_dpp v45, v34, v45 quad_perm:[2,2,2,2] row_mask:0xf bank_mask:0xf
    s_nop 0
    v_add_f32_dpp v44, v31, v44 quad_perm:[3,3,3,3] row_mask:0xf bank_mask:0xf
    v_add_f32_dpp v45, v35, v45 quad_perm:[3,3,3,3] row_mask:0xf bank_mask:0xf
    s_bitcmp1_b32 s52, 3
    s_cbranch_scc1 L_loop_w3
    s_waitcnt vmcnt(4)
L_loop_w3:
    s_add_u32 s33, s33, 0x20000
    s_and_b32 s33, s33, 0x3fffff
    s_sub_u32 s43, s43, 1
    buffer_load_dwordx4 v[152:155], v2, s[24:27], s33 offen offset:0 sc1 nt
    s_waitcnt vmcnt(5)
    v_mfma_f32_16x16x32_bf16 v[40:43], v[164:167], v[8:11], 0
    s_nop 3
    s_nop 3
    v_mov_b32_dpp v46, v36 quad_perm:[0,0,0,0] row_mask:0xf bank_mask:0xf
    v_mov_b32_dpp v47, v40 quad_perm:[0,0,0,0] row_mask:0xf bank_mask:0xf
    s_nop 0
    v_add_f32_dpp v46, v37, v46 quad_perm:[1,1,1,1] row_mask:0xf bank_mask:0xf
    v_add_f32_dpp v47, v41, v47 quad_perm:[1,1,1,1] row_mask:0xf bank_mask:0xf
    s_nop 0
    v_add_f32_dpp v46, v38, v46 quad_perm:[2,2,2,2] row_mask:0xf bank_mask:0xf
    v_add_f32_dpp v47, v42, v47 quad_perm:[2,2,2,2] row_mask:0xf bank_mask:0xf
    s_nop 0
    v_add_f32_dpp v46, v39, v46 quad_perm:[3,3,3,3] row_mask:0xf bank_mask:0xf
    v_add_f32_dpp v47, v43, v47 quad_perm:[3,3,3,3] row_mask:0xf bank_mask:0xf
    v_max3_f32 v22, v44, v45, v46
    v_max_f32 v22, v22, v47
    v_mul_f32 v22, s42, v22
    v_cmp_gt_f32 vcc, v22, v20
    s_cbranch_vccz L_keepL_loop
    s_call_b64 s[44:45], L_rescale
L_keepL_loop:
    v_fma_f32 v44, v44, s42, -v20
    v_exp_f32 v44, v44
    s_nop 0
    v_cvt_pk_bf16_f32 v49, v44, v44
    v_and_b32 v48, v49, v4
    v_and_b32 v49, v49, v5
    v_add_f32 v21, v21, v44
    s_bitcmp1_b32 s52, 4
    s_cbranch_scc1 L_loop_w4
    s_bitcmp0_b32 s52, 12
    s_cbranch_scc1 L_loop_v4
    s_waitcnt vmcnt(3)
L_loop_v4:
    s_waitcnt vmcnt(4)
L_loop_w4:
    buffer_load_dwordx4 v[156:159], v2, s[24:27], s33 offen offset:1024 sc1 nt
    s_waitcnt vmcnt(5)
    v_mfma_f32_16x16x16_bf16 v[12:15], v[48:49], v[168:169], v[12:15]
    v_mfma_f32_16x16x16_bf16 v[16:19], v[48:49], v[170:171], v[16:19]
    v_fma_f32 v45, v45, s42, -v20
    v_exp_f32 v45, v45
    s_nop 0
    v_cvt_pk_bf16_f32 v51, v45, v45
    v_and_b32 v50, v51, v4
    v_and_b32 v51, v51, v5
    v_add_f32 v21, v21, v45
    s_bitcmp1_b32 s52, 5
    s_cbranch_scc1 L_loop_w5
    s_waitcnt vmcnt(4)
L_loop_w5:
    buffer_load_dwordx4 v[160:163], v2, s[24:27], s33 offen offset:2048 sc1 nt
    s_waitcnt vmcnt(5)
    v_mfma_f32_16x16x16_bf16 v[12:15], v[50:51], v[172:173], v[12:15]
    v_mfma_f32_16x16x16_bf16 v[16:19], v[50:51], v[174:175], v[16:19]
    v_fma_f32 v46, v46, s42, -v20
    v_exp_f32 v46, v46
    s_nop 0
    v_cvt_pk_bf16_f32 v53, v46, v46
    v_and_b32 v52, v53, v4
    v_and_b32 v53, v53, v5
    v_add_f32 v21, v21, v46
    s_bitcmp1_b32 s52, 6
    s_cbranch_scc1 L_loop_w6
    s_waitcnt vmcnt(4)
L_loop_w6:
    buffer_load_dwordx4 v[164:167], v2, s[24:27], s33 offen offset:3072 sc1 nt
    s_waitcnt vmcnt(5)
    v_mfma_f32_16x16x16_bf16 v[12:15], v[52:53], v[176:177], v[12:15]
    v_mfma_f32_16x16x16_bf16 v[16:19], v[52:53], v[178:179], v[16:19]
    v_fma_f32 v47, v47, s42, -v20
    v_exp_f32 v47, v47
    s_nop 0
    v_cvt_pk_bf16_f32 v55, v47, v47
    v_and_b32 v54, v55, v4
    v_and_b32 v55, v55, v5
    v_add_f32 v21, v21, v47
    s_bitcmp1_b32 s52, 7
    s_cbranch_scc1 L_loop_w7
    s_waitcnt vmcnt(4)
L_loop_w7:
    buffer_load_dwordx4 v[168:171], v3, s[28:31], s33 offen offset:0 sc1 nt
    s_waitcnt vmcnt(5)
    v_mfma_f32_16x16x16_bf16 v[12:15], v[54:55], v[180:181], v[12:15]
    v_mfma_f32_16x16x16_bf16 v[16:19], v[54:55], v[182:183], v[16:19]
    s_bitcmp1_b32 s53, s43
    s_cbranch_scc0 L_loop_m
    s_call_b64 s[44:45], L_rank
L_loop_m:
    s_cmp_lg_u32 s43, 3
    s_cbranch_scc1 L_loop
    s_branch L_page2
L_rank:
    s_add_u32 s46, s46, 1
    v_mov_b32 v23, 0
    s_cmp_eq_u32 s46, 3
    s_cbranch_scc1 L_rank_take
    s_cmp_lg_u32 s20, 1
    s_cbranch_scc1 L_rank_ret
    s_cmp_eq_u32 s46, 2
    s_cbranch_scc1 L_rank_use
    s_mov_b32 s47, 1
    s_atomic_add s47, s[48:49], s41 glc
    s_add_u32 s41, s41, 4
L_rank_ret:
    s_setpc_b64 s[44:45]
L_rank_use:
    s_waitcnt lgkmcnt(0)
    s_and_b32 s47, s47, 7
    s_lshr_b32 m0, s47, 1
    s_lshl_b32 s47, s47, 4
    s_movrels_b32 s36, s84
    s_lshr_b32 s52, s36, s47
    s_and_b32 s52, s52, 0xffff
    v_mov_b32 v22, s52
    ds_write_b32 v23, v22 offset:25736
    s_setpc_b64 s[44:45]
L_rank_take:
    ds_read_b32 v23, v23 offset:25736
    s_mov_b32 s46, 0
    s_waitcnt lgkmcnt(0)
    v_readfirstlane_b32 s47, v23
    s_cmp_eq_u32 s47, -1
    s_cselect_b32 s52, s52, s47
    s_setpc_b64 s[44:45]
L_helper3:
    s_branch L_helper4
L_page2:
    buffer_load_dwordx4 v[172:175], v3, s[28:31], s33 offen offset:1024 sc1 nt
    buffer_load_dwordx4 v[176:179], v3, s[28:31], s33 offen offset:2048 sc1 nt
    buffer_load_dwordx4 v[180:183], v3, s[28:31], s33 offen offset:3072 sc1 nt
    s_sub_u32 s34, s20, 1
    v_lshrrev_b32 v6, 4, v1
    v_and_b32 v7, 15, v1
    v_lshlrev_b32 v56, 9, v6
    v_lshl_add_u32 v56, v7, 5, v56
    s_lshl_b32 s35, s34, 11
    v_add_u32 v56, s35, v56
    s_lshl_b32 s41, s34, 2
    v_lshl_add_u32 v57, v1, 2, s41
    v_and_b32 v58, 12, v1
    v_lshlrev_b32 v58, 2, v58
    s_lshl_b32 s35, s34, 9
    v_lshl_add_u32 v59, v1, 3, s35
    s_lshl_b32 s35, s34, 4
    v_mov_b32 v60, s35
    s_lshl_b32 s35, s56, 10
    s_lshl_b32 s36, s34, 8
    s_add_u32 s35, s35, s36
    s_add_u32 s35, s35, 262144
    v_lshl_add_u32 v61, v1, 2, s35
    s_lshl_b32 s35, s56, 4
    s_add_u32 s35, s35, s34
    s_lshl_b32 s35, s35, 3
    s_add_u32 s35, s35, 524288
    v_mov_b32 v62, s35
    v_mov_b32 v63, 0
L_loop2:
    s_waitcnt vmcnt(7)
    v_mfma_f32_16x16x32_bf16 v[28:31], v[152:155], v[8:11], 0
    s_add_u32 s33, s33, 0x20000
    s_and_b32 s33, s33, 0x3fffff
    s_sub_u32 s43, s43, 1
    buffer_load_dwordx4 v[152:155], v2, s[24:27], s33 offen offset:0 sc1 nt
    s_waitcnt vmcnt(7)
    v_mfma_f32_16x16x32_bf16 v[32:35], v[156:159], v[8:11], 0
    buffer_load_dwordx4 v[156:159], v2, s[24:27], s33 offen offset:1024 sc1 nt
    s_waitcnt vmcnt(7)
    v_mfma_f32_16x16x32_bf16 v[36:39], v[160:163], v[8:11], 0
    buffer_load_dwordx4 v[160:163], v2, s[24:27], s33 offen offset:2048 sc1 nt
    s_waitcnt vmcnt(7)
    v_mfma_f32_16x16x32_bf16 v[40:43], v[164:167], v[8:11], 0
    buffer_load_dwordx4 v[164:167], v2, s[24:27], s33 offen offset:3072 sc1 nt
    s_nop 5
    v_mov_b32_dpp v44, v28 quad_perm:[0,0,0,0] row_mask:0xf bank_mask:0xf
    v_mov_b32_dpp v45, v32 quad_perm:[0,0,0,0] row_mask:0xf bank_mask:0xf
    v_mov_b32_dpp v46, v36 quad_perm:[0,0,0,0] row_mask:0xf bank_mask:0xf
    v_mov_b32_dpp v47, v40 quad_perm:[0,0,0,0] row_mask:0xf bank_mask:0xf
    v_add_f32_dpp v44, v29, v44 quad_perm:[1,1,1,1] row_mask:0xf bank_mask:0xf
    v_add_f32_dpp v45, v33, v45 quad_perm:[1,1,1,1] row_mask:0xf bank_mask:0xf
    v_add_f32_dpp v46, v37, v46 quad_perm:[1,1,1,1] row_mask:0xf bank_mask:0xf
    v_add_f32_dpp v47, v41, v47 quad_perm:[1,1,1,1] row_mask:0xf bank_mask:0xf
    v_add_f32_dpp v44, v30, v44 quad_perm:[2,2,2,2] row_mask:0xf bank_mask:0xf
    v_add_f32_dpp v45, v34, v45 quad_perm:[2,2,2,2] row_mask:0xf bank_mask:0xf
    v_add_f32_dpp v46, v38, v46 quad_perm:[2,2,2,2] row_mask:0xf bank_mask:0xf
    v_add_f32_dpp v47, v42, v47 quad_perm:[2,2,2,2] row_mask:0xf bank_mask:0xf
    v_add_f32_dpp v44, v31, v44 quad_perm:[3,3,3,3] row_mask:0xf bank_mask:0xf
    v_add_f32_dpp v45, v35, v45 quad_perm:[3,3,3,3] row_mask:0xf bank_mask:0xf
    v_add_f32_dpp v46, v39, v46 quad_perm:[3,3,3,3] row_mask:0xf bank_mask:0xf
    v_add_f32_dpp v47, v43, v47 quad_perm:[3,3,3,3] row_mask:0xf bank_mask:0xf
    v_max3_f32 v22, v44, v45, v46
    v_max_f32 v22, v22, v47
    v_mul_f32 v22, s42, v22
    v_cmp_gt_f32 vcc, v22, v20
    s_cbranch_vccz L_keepL_loop2
    s_call_b64 s[44:45], L_rescale
L_keepL_loop2:
    v_fma_f32 v44, v44, s42, -v20
    v_fma_f32 v45, v45, s42, -v20
    v_fma_f32 v46, v46, s42, -v20
    v_fma_f32 v47, v47, s42, -v20
    v_exp_f32 v44, v44
    v_exp_f32 v45, v45
    v_exp_f32 v46, v46
    v_exp_f32 v47, v47
    v_cvt_pk_bf16_f32 v49, v44, v44
    v_cvt_pk_bf16_f32 v51, v45, v45
    v_cvt_pk_bf16_f32 v53, v46, v46
    v_cvt_pk_bf16_f32 v55, v47, v47
    v_add_f32 v44, v44, v45
    v_add_f32 v46, v46, v47
    v_and_b32 v48, v49, v4
    v_and_b32 v49, v49, v5
    v_and_b32 v50, v51, v4
    v_and_b32 v51, v51, v5
    v_and_b32 v52, v53, v4
    v_and_b32 v53, v53, v5
    v_and_b32 v54, v55, v4
    v_and_b32 v55, v55, v5
    v_add_f32 v21, v21, v44
    v_add_f32 v21, v21, v46
    s_waitcnt vmcnt(7)
    v_mfma_f32_16x16x16_bf16 v[12:15], v[48:49], v[168:169], v[12:15]
    v_mfma_f32_16x16x16_bf16 v[16:19], v[48:49], v[170:171], v[16:19]
    buffer_load_dwordx4 v[168:171], v3, s[28:31], s33 offen offset:0 sc1 nt
    s_waitcnt vmcnt(7)
    v_mfma_f32_16x16x16_bf16 v[12:15], v[50:51], v[172:173], v[12:15]
    v_mfma_f32_16x16x16_bf16 v[16:19], v[50:51], v[174:175], v[16:19]
    buffer_load_dwordx4 v[172:175], v3, s[28:31], s33 offen offset:1024 sc1 nt
    s_waitcnt vmcnt(7)
    v_mfma_f32_16x16x16_bf16 v[12:15], v[52:53], v[176:177], v[12:15]
    v_mfma_f32_16x16x16_bf16 v[16:19], v[52:53], v[178:179], v[16:19]
    buffer_load_dwordx4 v[176:179], v3, s[28:31], s33 offen offset:2048 sc1 nt
    s_waitcnt vmcnt(7)
    v_mfma_f32_16x16x16_bf16 v[12:15], v[54:55], v[180:181], v[12:15]
    v_mfma_f32_16x16x16_bf16 v[16:19], v[54:55], v[182:183], v[16:19]
    buffer_load_dwordx4 v[180:183], v3, s[28:31], s33 offen offset:3072 sc1 nt
    s_cmp_lg_u32 s43, 1
    s_cbranch_scc1 L_loop2
    s_waitcnt vmcnt(7)
    v_mfma_f32_16x16x32_bf16 v[28:31], v[152:155], v[8:11], 0
    s_waitcnt vmcnt(6)
    v_mfma_f32_16x16x32_bf16 v[32:35], v[156:159], v[8:11], 0
    s_waitcnt vmcnt(5)
    v_mfma_f32_16x16x32_bf16 v[36:39], v[160:163], v[8:11], 0
    s_waitcnt vmcnt(4)
    v_mfma_f32_16x16x32_bf16 v[40:43], v[164:167], v[8:11], 0
    s_nop 5
    v_mov_b32_dpp v44, v28 quad_perm:[0,0,0,0] row_mask:0xf bank_mask:0xf
    v_mov_b32_dpp v45, v32 quad_perm:[0,0,0,0] row_mask:0xf bank_mask:0xf
    v_mov_b32_dpp v46, v36 quad_perm:[0,0,0,0] row_mask:0xf bank_mask:0xf
    v_mov_b32_dpp v47, v40 quad_perm:[0,0,0,0] row_mask:0xf bank_mask:0xf
    v_add_f32_dpp v44, v29, v44 quad_perm:[1,1,1,1] row_mask:0xf bank_mask:0xf
    v_add_f32_dpp v45, v33, v45 quad_perm:[1,1,1,1] row_mask:0xf bank_mask:0xf
    v_add_f32_dpp v46, v37, v46 quad_perm:[1,1,1,1] row_mask:0xf bank_mask:0xf
    v_add_f32_dpp v47, v41, v47 quad_perm:[1,1,1,1] row_mask:0xf bank_mask:0xf
    v_add_f32_dpp v44, v30, v44 quad_perm:[2,2,2,2] row_mask:0xf bank_mask:0xf
    v_add_f32_dpp v45, v34, v45 quad_perm:[2,2,2,2] row_mask:0xf bank_mask:0xf
    v_add_f32_dpp v46, v38, v46 quad_perm:[2,2,2,2] row_mask:0xf bank_mask:0xf
    v_add_f32_dpp v47, v42, v47 quad_perm:[2,2,2,2] row_mask:0xf bank_mask:0xf
    v_add_f32_dpp v44, v31, v44 quad_perm:[3,3,3,3] row_mask:0xf bank_mask:0xf
    v_add_f32_dpp v45, v35, v45 quad_perm:[3,3,3,3] row_mask:0xf bank_mask:0xf
    v_add_f32_dpp v46, v39, v46 quad_perm:[3,3,3,3] row_mask:0xf bank_mask:0xf
    v_add_f32_dpp v47, v43, v47 quad_perm:[3,3,3,3] row_mask:0xf bank_mask:0xf
    v_max3_f32 v22, v44, v45, v46
    v_max_f32 v22, v22, v47
    v_mul_f32 v22, s42, v22
    v_mov_b32 v23, v22
    s_nop 1
    v_permlane16_swap_b32 v22, v23
    s_nop 1
    v_max_f32 v22, v22, v23
    v_mov_b32 v23, v22
    s_nop 1
    v_permlane32_swap_b32 v22, v23
    s_nop 1
    v_max3_f32 v22, v22, v23, v20
    s_mov_b64 exec, 0x1111
    ds_write_b32 v57, v22 offset:25600
    s_mov_b64 exec, -1
    s_waitcnt lgkmcnt(0)
    s_barrier
    ds_read_b128 v[28:31], v58 offset:25600
    ds_read_b32 v63, v63 offset:25732
    s_waitcnt lgkmcnt(1)
    v_max3_f32 v22, v28, v29, v30
    v_max_f32 v22, v22, v31
    v_sub_f32 v24, v20, v22
    v_exp_f32 v24, v24
    v_mov_b32 v20, v22
    v_mul_f32 v21, v21, v24
    s_nop 0
    v_mov_b32_dpp v25, v24 row_newbcast:0 row_mask:0x1 bank_mask:0xf
    s_nop 1
    v_mov_b32_dpp v25, v24 row_newbcast:4 row_mask:0x2 bank_mask:0xf
    s_nop 1
    v_mov_b32_dpp v25, v24 row_newbcast:8 row_mask:0x4 bank_mask:0xf
    s_nop 1
    v_mov_b32_dpp v25, v24 row_newbcast:12 row_mask:0x8 bank_mask:0xf
    s_nop 1
    v_mul_f32 v12, v12, v25
    v_mul_f32 v13, v13, v25
    v_mul_f32 v14, v14, v25
    v_mul_f32 v15, v15, v25
    v_mul_f32 v16, v16, v25
    v_mul_f32 v17, v17, v25
    v_mul_f32 v18, v18, v25
    v_mul_f32 v19, v19, v25
    v_fma_f32 v44, v44, s42, -v20
    v_fma_f32 v45, v45, s42, -v20
    v_fma_f32 v46, v46, s42, -v20
    v_fma_f32 v47, v47, s42, -v20
    v_exp_f32 v44, v44
    v_exp_f32 v45, v45
    v_exp_f32 v46, v46
    v_exp_f32 v47, v47
    v_cvt_pk_bf16_f32 v49, v44, v44
    v_cvt_pk_bf16_f32 v51, v45, v45
    v_cvt_pk_bf16_f32 v53, v46, v46
    v_cvt_pk_bf16_f32 v55, v47, v47
    v_add_f32 v44, v44, v45
    v_add_f32 v46, v46, v47
    v_and_b32 v48, v49, v4
    v_and_b32 v49, v49, v5
    v_and_b32 v50, v51, v4
    v_and_b32 v51, v51, v5
    v_and_b32 v52, v53, v4
    v_and_b32 v53, v53, v5
    v_and_b32 v54, v55, v4
    v_and_b32 v55, v55, v5
    v_add_f32 v21, v21, v44
    v_add_f32 v21, v21, v46
    v_mov_b32 v23, v21
    v_readlane_b32 s50, v20, s41
    s_waitcnt lgkmcnt(0)
    v_permlane16_swap_b32 v21, v23
    v_cmp_eq_u32 vcc, 1, v63
    s_min_u32 s50, s50, -2
    v_add_f32 v21, v21, v23
    v_mov_b32 v23, v21
    v_mov_b32 v44, s50
    s_nop 0
    v_permlane32_swap_b32 v21, v23
    s_nop 0
    v_add_f32 v21, v21, v23
    s_mov_b64 exec, 0x1111
    ds_write_b32 v57, v21 offset:25664
    s_mov_b64 exec, -1
    s_waitcnt vmcnt(3)
    v_mfma_f32_16x16x16_bf16 v[12:15], v[48:49], v[168:169], v[12:15]
    v_mfma_f32_16x16x16_bf16 v[16:19], v[48:49], v[170:171], v[16:19]
    s_waitcnt vmcnt(2)
    v_mfma_f32_16x16x16_bf16 v[12:15], v[50:51], v[172:173], v[12:15]
    v_mfma_f32_16x16x16_bf16 v[16:19], v[50:51], v[174:175], v[16:19]
    s_waitcnt vmcnt(1)
    v_mfma_f32_16x16x16_bf16 v[12:15], v[52:53], v[176:177], v[12:15]
    v_mfma_f32_16x16x16_bf16 v[16:19], v[52:53], v[178:179], v[16:19]
    s_waitcnt vmcnt(0)
    v_mfma_f32_16x16x16_bf16 v[12:15], v[54:55], v[180:181], v[12:15]
    v_mfma_f32_16x16x16_bf16 v[16:19], v[54:55], v[182:183], v[16:19]
    s_nop 6
    ds_write_b128 v56, v[12:15] offset:17408
    ds_write_b128 v56, v[16:19] offset:17424
    s_waitcnt lgkmcnt(0)
    s_barrier
    ds_read_b64 v[36:37], v59 offset:17408
    ds_read_b64 v[38:39], v59 offset:19456
    ds_read_b64 v[40:41], v59 offset:21504
    ds_read_b64 v[42:43], v59 offset:23552
    ds_read_b128 v[32:35], v60 offset:25664
    s_waitcnt lgkmcnt(3)
    v_add_f32 v36, v36, v38
    v_add_f32 v37, v37, v39
    s_waitcnt lgkmcnt(1)
    v_add_f32 v40, v40, v42
    v_add_f32 v41, v41, v43
    v_add_f32 v36, v36, v40
    v_add_f32 v37, v37, v41
    v_cvt_pk_bf16_f32 v48, v36, v37
    s_waitcnt lgkmcnt(0)
    v_min_u32 v48, -2, v48
    v_add_f32 v32, v32, v33
    v_add_f32 v34, v34, v35
    v_mov_b32_dpp v49, v48 quad_perm:[1,1,1,1] row_mask:0xf bank_mask:0xf
    v_mov_b32_dpp v50, v48 quad_perm:[2,2,2,2] row_mask:0xf bank_mask:0xf
    v_mov_b32_dpp v51, v48 quad_perm:[3,3,3,3] row_mask:0xf bank_mask:0xf
    v_add_f32 v45, v32, v34
    s_mov_b32 exec_lo, 0x11111111
    s_mov_b32 exec_hi, 0x11111111
    v_min_u32 v45, -2, v45
    s_cbranch_vccz L_pub_far
    global_store_dwordx4 v61, v[48:51], s[18:19]
    s_mov_b64 exec, 1
    global_store_dwordx2 v62, v[44:45], s[18:19]
    s_endpgm
L_pub_far:
    global_store_dwordx4 v61, v[48:51], s[18:19] sc1
    s_mov_b64 exec, 1
    global_store_dwordx2 v62, v[44:45], s[18:19] sc1
L_pub_done:
    s_endpgm
L_helper4:
    s_barrier
    global_load_dwordx2 v[20:21], v17, s[18:19] sc1
    global_load_dwordx4 v[96:99], v15, s[18:19] offset:0 sc1
    global_load_dwordx4 v[100:103], v15, s[18:19] offset:64 sc1
    global_load_dwordx4 v[104:107], v15, s[18:19] offset:128 sc1
    global_load_dwordx4 v[108:111], v15, s[18:19] offset:192 sc1
    global_load_dwordx4 v[112:115], v16, s[18:19] offset:0 sc1
    global_load_dwordx4 v[116:119], v16, s[18:19] offset:64 sc1
    global_load_dwordx4 v[120:123], v16, s[18:19] offset:128 sc1
    global_load_dwordx4 v[124:127], v16, s[18:19] offset:192 sc1
    s_barrier
    s_branch L_chk1
L_poll1:
    global_load_dwordx2 v[20:21], v17, s[18:19] sc1
    global_load_dwordx4 v[96:99], v15, s[18:19] offset:0 sc1
    global_load_dwordx4 v[100:103], v15, s[18:19] offset:64 sc1
    global_load_dwordx4 v[104:107], v15, s[18:19] offset:128 sc1
    global_load_dwordx4 v[108:111], v15, s[18:19] offset:192 sc1
    global_load_dwordx4 v[112:115], v16, s[18:19] offset:0 sc1
    global_load_dwordx4 v[116:119], v16, s[18:19] offset:64 sc1
    global_load_dwordx4 v[120:123], v16, s[18:19] offset:128 sc1
    global_load_dwordx4 v[124:127], v16, s[18:19] offset:192 sc1
L_chk1:
    s_add_u32 s49, s49, 1
    s_waitcnt vmcnt(8)
    v_max_u32 v22, v20, v21
    s_waitcnt vmcnt(7)
    v_max3_u32 v22, v22, v96, v97
    v_max3_u32 v22, v22, v98, v99
    s_waitcnt vmcnt(6)
    v_max3_u32 v22, v22, v100, v101
    v_max3_u32 v22, v22, v102, v103
    s_waitcnt vmcnt(5)
    v_max3_u32 v22, v22, v104, v105
    v_max3_u32 v22, v22, v106, v107
    s_waitcnt vmcnt(4)
    v_max3_u32 v22, v22, v108, v109
    v_max3_u32 v22, v22, v110, v111
    s_waitcnt vmcnt(3)
    v_max3_u32 v22, v22, v112, v113
    v_max3_u32 v22, v22, v114, v115
    s_waitcnt vmcnt(2)
    v_max3_u32 v22, v22, v116, v117
    v_max3_u32 v22, v22, v118, v119
    s_waitcnt vmcnt(1)
    v_max3_u32 v22, v22, v120, v121
    v_max3_u32 v22, v22, v122, v123
    s_waitcnt vmcnt(0)
    v_max3_u32 v22, v22, v124, v125
    v_max3_u32 v22, v22, v126, v127
    v_cmp_eq_u32 vcc, -1, v22
    s_cmp_ge_u32 s49, 2000000
    s_cbranch_scc1 L_got1
    s_and_b64 exec, exec, vcc
    s_cbranch_scc1 L_poll1
L_got1:
    s_mov_b64 exec, -1
    v_mfma_f32_16x16x32_bf16 v[128:131], v[96:99], v[32:35], 0
    v_max_f32_dpp v22, v20, v20 row_ror:1 row_mask:0xf bank_mask:0xf
    s_nop 0
    v_mfma_f32_16x16x32_bf16 v[132:135], v[96:99], v[36:39], 0
    v_max_f32_dpp v22, v22, v22 row_ror:2 row_mask:0xf bank_mask:0xf
    s_nop 0
    v_mfma_f32_16x16x32_bf16 v[136:139], v[96:99], v[40:43], 0
    v_max_f32_dpp v22, v22, v22 row_ror:4 row_mask:0xf bank_mask:0xf
    s_nop 0
    v_mfma_f32_16x16x32_bf16 v[140:143], v[96:99], v[44:47], 0
    v_sub_f32 v22, v20, v22
    s_nop 0
    v_mfma_f32_16x16x32_bf16 v[128:131], v[100:103], v[48:51], v[128:131]
    v_exp_f32 v22, v22
    s_nop 0
    v_mfma_f32_16x16x32_bf16 v[132:135], v[100:103], v[52:55], v[132:135]
    v_mul_f32 v23, v22, v21
    s_nop 0
    v_mfma_f32_16x16x32_bf16 v[136:139], v[100:103], v[56:59], v[136:139]
    v_add_f32_dpp v23, v23, v23 row_ror:1 row_mask:0xf bank_mask:0xf
    s_nop 0
    v_mfma_f32_16x16x32_bf16 v[140:143], v[100:103], v[60:63], v[140:143]
    v_add_f32_dpp v23, v23, v23 row_ror:2 row_mask:0xf bank_mask:0xf
    s_nop 0
    v_mfma_f32_16x16x32_bf16 v[128:131], v[104:107], v[64:67], v[128:131]
    v_add_f32_dpp v23, v23, v23 row_ror:4 row_mask:0xf bank_mask:0xf
    s_nop 0
    v_mfma_f32_16x16x32_bf16 v[132:135], v[104:107], v[68:71], v[132:135]
    v_rcp_f32 v23, v23
    s_nop 0
    v_mfma_f32_16x16x32_bf16 v[136:139], v[104:107], v[72:75], v[136:139]
    v_mul_f32 v22, v22, v23
    s_nop 0
    v_mfma_f32_16x16x32_bf16 v[140:143], v[104:107], v[76:79], v[140:143]
    v_mfma_f32_16x16x32_bf16 v[128:131], v[108:111], v[80:83], v[128:131]
    v_mfma_f32_16x16x32_bf16 v[132:135], v[108:111], v[84:87], v[132:135]
    v_mfma_f32_16x16x32_bf16 v[136:139], v[108:111], v[88:91], v[136:139]
    v_mfma_f32_16x16x32_bf16 v[140:143], v[108:111], v[92:95], v[140:143]
    v_mfma_f32_16x16x32_bf16 v[144:147], v[112:115], v[32:35], 0
    v_mfma_f32_16x16x32_bf16 v[148:151], v[112:115], v[36:39], 0
    v_mfma_f32_16x16x32_bf16 v[152:155], v[112:115], v[40:43], 0
    v_mfma_f32_16x16x32_bf16 v[156:159], v[112:115], v[44:47], 0
    v_mfma_f32_16x16x32_bf16 v[144:147], v[116:119], v[48:51], v[144:147]
    v_mfma_f32_16x16x32_bf16 v[148:151], v[116:119], v[52:55], v[148:151]
    v_mfma_f32_16x16x32_bf16 v[152:155], v[116:119], v[56:59], v[152:155]
    v_mfma_f32_16x16x32_bf16 v[156:159], v[116:119], v[60:63], v[156:159]
    v_mul_f32_dpp v24, v22, v128 row_newbcast:0 row_mask:0xf bank_mask:0xf
    v_mul_f32_dpp v25, v22, v132 row_newbcast:0 row_mask:0xf bank_mask:0xf
    v_mfma_f32_16x16x32_bf16 v[144:147], v[120:123], v[64:67], v[144:147]
    v_mul_f32_dpp v26, v22, v136 row_newbcast:0 row_mask:0xf bank_mask:0xf
    v_mul_f32_dpp v27, v22, v140 row_newbcast:0 row_mask:0xf bank_mask:0xf
    v_mfma_f32_16x16x32_bf16 v[148:151], v[120:123], v[68:71], v[148:151]
    v_fmac_f32_dpp v24, v22, v129 row_newbcast:1 row_mask:0xf bank_mask:0xf
    v_fmac_f32_dpp v25, v22, v133 row_newbcast:1 row_mask:0xf bank_mask:0xf
    v_mfma_f32_16x16x32_bf16 v[152:155], v[120:123], v[72:75], v[152:155]
    v_fmac_f32_dpp v26, v22, v137 row_newbcast:1 row_mask:0xf bank_mask:0xf
    v_fmac_f32_dpp v27, v22, v141 row_newbcast:1 row_mask:0xf bank_mask:0xf
    v_mfma_f32_16x16x32_bf16 v[156:159], v[120:123], v[76:79], v[156:159]
    v_fmac_f32_dpp v24, v22, v130 row_newbcast:2 row_mask:0xf bank_mask:0xf
    v_fmac_f32_dpp v25, v22, v134 row_newbcast:2 row_mask:0xf bank_mask:0xf
    v_mfma_f32_16x16x32_bf16 v[144:147], v[124:127], v[80:83], v[144:147]
    v_fmac_f32_dpp v26, v22, v138 row_newbcast:2 row_mask:0xf bank_mask:0xf
    v_fmac_f32_dpp v27, v22, v142 row_newbcast:2 row_mask:0xf bank_mask:0xf
    v_mfma_f32_16x16x32_bf16 v[148:151], v[124:127], v[84:87], v[148:151]
    v_fmac_f32_dpp v24, v22, v131 row_newbcast:3 row_mask:0xf bank_mask:0xf
    v_fmac_f32_dpp v25, v22, v135 row_newbcast:3 row_mask:0xf bank_mask:0xf
    v_mfma_f32_16x16x32_bf16 v[152:155], v[124:127], v[88:91], v[152:155]
    v_fmac_f32_dpp v26, v22, v139 row_newbcast:3 row_mask:0xf bank_mask:0xf
    v_fmac_f32_dpp v27, v22, v143 row_newbcast:3 row_mask:0xf bank_mask:0xf
    v_mfma_f32_16x16x32_bf16 v[156:159], v[124:127], v[92:95], v[156:159]
    s_nop 4
    v_fmac_f32_dpp v24, v22, v144 row_newbcast:4 row_mask:0xf bank_mask:0xf
    v_fmac_f32_dpp v25, v22, v148 row_newbcast:4 row_mask:0xf bank_mask:0xf
    v_fmac_f32_dpp v26, v22, v152 row_newbcast:4 row_mask:0xf bank_mask:0xf
    v_fmac_f32_dpp v27, v22, v156 row_newbcast:4 row_mask:0xf bank_mask:0xf
    v_fmac_f32_dpp v24, v22, v145 row_newbcast:5 row_mask:0xf bank_mask:0xf
    v_fmac_f32_dpp v25, v22, v149 row_newbcast:5 row_mask:0xf bank_mask:0xf
    v_fmac_f32_dpp v26, v22, v153 row_newbcast:5 row_mask:0xf bank_mask:0xf
    v_fmac_f32_dpp v27, v22, v157 row_newbcast:5 row_mask:0xf bank_mask:0xf
    v_fmac_f32_dpp v24, v22, v146 row_newbcast:6 row_mask:0xf bank_mask:0xf
    v_fmac_f32_dpp v25, v22, v150 row_newbcast:6 row_mask:0xf bank_mask:0xf
    v_fmac_f32_dpp v26, v22, v154 row_newbcast:6 row_mask:0xf bank_mask:0xf
    v_fmac_f32_dpp v27, v22, v158 row_newbcast:6 row_mask:0xf bank_mask:0xf
    v_fmac_f32_dpp v24, v22, v147 row_newbcast:7 row_mask:0xf bank_mask:0xf
    v_fmac_f32_dpp v25, v22, v151 row_newbcast:7 row_mask:0xf bank_mask:0xf
    v_fmac_f32_dpp v26, v22, v155 row_newbcast:7 row_mask:0xf bank_mask:0xf
    v_fmac_f32_dpp v27, v22, v159 row_newbcast:7 row_mask:0xf bank_mask:0xf
    s_cmp_eq_u32 s59, 1
    s_mov_b32 s49, 0
    v_min_u32 v24, -2, v24
    v_min_u32 v25, -2, v25
    v_min_u32 v26, -2, v26
    v_min_u32 v27, -2, v27
    s_cbranch_scc1 L_p2_near
    global_store_dwordx4 v12, v[24:27], s[18:19] sc1
    s_branch L_p2_done
L_p2_near:
    global_store_dwordx4 v12, v[24:27], s[18:19]
L_p2_done:
L_poll2:
L_poll2a:
    global_load_dwordx4 v[28:31], v18, s[18:19] sc1
    s_add_u32 s49, s49, 1
    s_waitcnt vmcnt(0)
    v_max3_u32 v22, v28, v29, v30
    v_max_u32 v22, v22, v31
    v_cmp_eq_u32 vcc, -1, v22
    s_cmp_ge_u32 s49, 2000000
    s_cbranch_scc1 L_got2
    s_and_b64 exec, exec, vcc
    s_cbranch_scc1 L_poll2
L_got2:
    s_mov_b64 exec, -1
    v_permlane32_swap_b32 v28, v29
    v_permlane32_swap_b32 v30, v31
    s_nop 1
    v_add_f32 v28, v28, v29
    v_add_f32 v30, v30, v31
    s_nop 1
    v_permlane16_swap_b32 v28, v30
    s_nop 1
    v_add_f32 v28, v28, v30
    s_nop 1
    v_add_f32_dpp v28, v28, v28 row_ror:2 row_mask:0xf bank_mask:0xf
    s_nop 1
    v_add_f32_dpp v28, v28, v28 row_ror:4 row_mask:0xf bank_mask:0xf
    s_nop 1
    v_add_f32_dpp v28, v28, v28 row_ror:8 row_mask:0xf bank_mask:0xf
    s_nop 1
    v_mov_b32_dpp v29, v28 quad_perm:[1,1,1,1] row_mask:0xf bank_mask:0xf
    s_mov_b32 exec_lo, 0x00010001
    s_mov_b32 exec_hi, 0x00010001
    v_cvt_pk_bf16_f32 v28, v28, v29
    global_store_dword v19, v28, s[14:15]
L_end:
    s_endpgm
L_code_end:
.section .rodata,"a"
.p2align 6
.amdhsa_kernel standalone__gqa_block_cached__decode_kernel
.amdhsa_next_free_vgpr 248
.amdhsa_next_free_sgpr 96
.amdhsa_accum_offset 248
.amdhsa_group_segment_fixed_size 0
.amdhsa_kernarg_size 64
.amdhsa_user_sgpr_count 2
.amdhsa_user_sgpr_kernarg_segment_ptr 1
.amdhsa_system_sgpr_workgroup_id_x 1
.amdhsa_float_denorm_mode_32 3
.end_amdhsa_kernel
```
